```python
import torch

def _softmax(x, axis=-1):
    return torch.softmax(x, dim=axis)

def _gelu(x):
    return torch.nn.functional.gelu(x, approximate='tanh')

def _silu(x):
    return torch.nn.functional.silu(x)

def _sigmoid(x):
    return torch.sigmoid(x)

def _layernorm(x, axis=-1, eps=1e-05):
    m = x.mean(dim=axis, keepdim=True)
    v = x.var(dim=axis, keepdim=True, unbiased=False)
    return (x - m) / torch.sqrt(v + eps)

def _scatter_add(tgt, idx, src, axis=0):
    return tgt.clone().index_add_(axis, idx, src)

def _segment_sum(src, seg, n):
    out = torch.zeros((n,) + src.shape[1:], dtype=src.dtype)
    return out.index_add_(0, seg, src)

def _pad(x, pw):
    flat = tuple((v for pair in reversed(pw) for v in pair))
    return torch.nn.functional.pad(x, flat)
kernel_name = 'standalone__video_timesformer__vision'

def setup_inputs():

    _w = lambda a: (lambda t: t.to(torch.bfloat16) if t.is_floating_point() else t)(torch.as_tensor(a))
    T = 8
    p = 16
    HW = 256 // p * p
    N = (HW // p) ** 2
    C = 384
    return {'x': _w((lambda *s: torch.randn(*s, dtype=torch.bfloat16) * 0.05)(1, T, N, C)), 'wqkv_t': _w((lambda *s: torch.randn(*s, dtype=torch.bfloat16) * 0.05)(C, 3 * C)), 'wo_t': _w((lambda *s: torch.randn(*s, dtype=torch.bfloat16) * 0.05)(C, C)), 'wqkv_s': _w((lambda *s: torch.randn(*s, dtype=torch.bfloat16) * 0.05)(C, 3 * C)), 'wo_s': _w((lambda *s: torch.randn(*s, dtype=torch.bfloat16) * 0.05)(C, C))}

def reference(x, wqkv_t, wo_t, wqkv_s, wo_s):
    B, T, N, C = x.shape
    scale = C ** (-0.5)
    xt = (lambda x, *d: x.permute(*d))(x, 0, 2, 1, 3).reshape(B * N, T, C)
    h = _layernorm(xt, axis=-1)
    qkv = h @ wqkv_t
    q, k, v = (qkv[..., :C].clone(), qkv[..., C:2 * C].clone(), qkv[..., 2 * C:].clone())
    a = _softmax(torch.einsum('btc,bsc->bts', q, k) * scale, axis=-1)
    xt = xt + torch.einsum('bts,bsc->btc', a, v) @ wo_t
    x1 = (lambda x, *d: x.permute(*d))(xt.reshape(B, N, T, C), 0, 2, 1, 3)
    xs = x1.reshape(B * T, N, C)
    h = _layernorm(xs, axis=-1)
    qkv = h @ wqkv_s
    q, k, v = (qkv[..., :C].clone(), qkv[..., C:2 * C].clone(), qkv[..., 2 * C:].clone())
    a = _softmax(torch.einsum('bnc,bmc->bnm', q, k) * scale, axis=-1)
    xs = xs + torch.einsum('bnm,bmc->bnc', a, v) @ wo_s
    return xs.reshape(B, T, N, C)
```

```asm
; @launch grid=(256,1,1) block=(256,1,1) lds=154624
.amdgcn_target "amdgcn-amd-amdhsa--gfx950"
.text
.globl standalone__video_timesformer__vision_kernel
.p2align 8
.type standalone__video_timesformer__vision_kernel,@function
standalone__video_timesformer__vision_kernel:
    s_cmp_ge_u32 s2, 256
    s_cbranch_scc1 L_end
    s_load_dwordx16 s[4:19], s[0:1], 0
    s_and_b32 s20, s2, 7
    s_lshr_b32 s21, s2, 3
    v_lshrrev_b32 v4, 6, v0
    v_and_b32 v1, 63, v0
    v_readfirstlane_b32 s22, v4
    v_and_b32 v2, 15, v0
    v_bfe_u32 v3, v0, 4, 2
    v_lshlrev_b32 v68, 4, v1
    s_getpc_b64 s[56:57]
L_pc:
    s_lshl_b32 s27, s21, 2
    s_add_u32 s27, s27, s22
    s_mul_i32 s27, s27, 384
    s_min_u32 s27, s27, L_code_end-L_pc-384
    v_lshlrev_b32 v4, 7, v1
    v_add_u32 v5, s27, v4
    s_mov_b64 exec, 7
    global_load_dword v254, v5, s[56:57]
    s_mov_b64 exec, -1
    s_lshr_b32 s59, s21, 3
    s_and_b32 s60, s21, 7
    s_lshl_b32 s25, s59, 3
    s_add_u32 s25, s25, s20
    s_mov_b32 s39, 0x20000
    s_mov_b32 s43, 0x20000
    s_mov_b32 s35, 0x20000
    s_mov_b32 s34, 6615040
    s_cmp_ge_u32 s60, 6
    s_cbranch_scc1 L_products
    v_lshrrev_b32 v5, 3, v1
    v_mul_u32_u24 v6, 2304, v5
    v_and_b32 v5, 2, v5
    v_and_b32 v7, 7, v1
    v_xor_b32 v7, v7, v5
    v_lshl_add_u32 v6, v7, 4, v6
    v_add_u32 v200, 4096, v6
    v_xor_b32 v7, 64, v6
    v_add_u32 v201, 21504, v7
    v_add_u32 v202, 2816, v6
    v_add_u32 v203, 20224, v7
    s_mul_i32 s66, s22, 36864
    s_lshl_b32 s28, s60, 7
    s_add_u32 s66, s66, s28
    s_lshl_b32 s67, s22, 12
    v_lshrrev_b32 v4, 3, v1
    v_mul_u32_u24 v6, 196608, v4
    v_lshrrev_b32 v4, 1, v4
    v_and_b32 v5, 7, v1
    v_xor_b32 v5, v5, v4
    v_lshl_add_u32 v6, v5, 4, v6
    v_add_u32 v206, 1024, v6
    v_xor_b32 v6, 64, v6
    v_add_u32 v207, 768, v6
    s_lshl_b32 s27, s25, 2
    s_add_u32 s27, s27, s22
    s_mul_i32 s26, s27, 1536
    s_lshl_b32 s64, s26, 1
    s_mul_i32 s72, s22, 12288
    s_add_u32 s72, s72, 98304
    s_mov_b32 m0, s72
    s_waitcnt lgkmcnt(0)
    s_load_dword s23, s[18:19], 0
    s_sub_u32 s36, s4, 1024
    s_subb_u32 s37, s5, 0
    s_mov_b32 s38, 1573888
    s_sub_u32 s40, s6, 4096
    s_subb_u32 s41, s7, 0
    s_mov_b32 s42, 888832
    buffer_load_dwordx4 v206, s[36:39], s26 offen nt lds
    buffer_load_dwordx4 v207, s[36:39], s26 offen offset:1024 nt lds
    s_add_u32 m0, m0, 2048
    s_add_u32 s26, s26, 128
    buffer_load_dwordx4 v206, s[36:39], s26 offen nt lds
    buffer_load_dwordx4 v207, s[36:39], s26 offen offset:1024 nt lds
    s_add_u32 m0, m0, 2048
    s_add_u32 s26, s26, 128
    buffer_load_dwordx4 v206, s[36:39], s26 offen nt lds
    buffer_load_dwordx4 v207, s[36:39], s26 offen offset:1024 nt lds
    s_add_u32 m0, m0, 2048
    s_add_u32 s26, s26, 128
    buffer_load_dwordx4 v206, s[36:39], s26 offen nt lds
    buffer_load_dwordx4 v207, s[36:39], s26 offen offset:1024 nt lds
    s_add_u32 m0, m0, 2048
    s_add_u32 s26, s26, 128
    buffer_load_dwordx4 v206, s[36:39], s26 offen nt lds
    buffer_load_dwordx4 v207, s[36:39], s26 offen offset:1024 nt lds
    s_add_u32 m0, m0, 2048
    s_add_u32 s26, s26, 128
    buffer_load_dwordx4 v206, s[36:39], s26 offen nt lds
    buffer_load_dwordx4 v207, s[36:39], s26 offen offset:1024 nt lds
    s_mov_b32 m0, s67
    s_add_u32 s67, s67, 16384
    buffer_load_dwordx4 v200, s[40:43], s66 offen offset:0 lds
    buffer_load_dwordx4 v201, s[40:43], s66 offen offset:1024 lds
    buffer_load_dwordx4 v202, s[40:43], s66 offen offset:2048 lds
    buffer_load_dwordx4 v203, s[40:43], s66 offen offset:3072 lds
    s_add_u32 s66, s66, 147456
    s_branch L_main
L_products:
    s_lshl_b32 s27, s59, 1
    s_add_u32 s27, s27, s60
    s_sub_u32 s27, s27, 6
    s_mul_i32 s64, s20, 5
    s_add_u32 s64, s64, s27
    s_sub_u32 s64, s64, 3
    s_cmp_ge_u32 s64, 36
    s_cselect_b32 s64, 60, s64
    s_mul_i32 s28, s20, 3
    s_add_u32 s28, s28, s27
    s_add_u32 s28, s28, 36
    s_cmp_lt_u32 s27, 3
    s_cselect_b32 s64, s28, s64
    s_mul_hi_u32 s66, s64, 715827883
    s_mul_i32 s27, s66, 6
    s_sub_u32 s67, s64, s27
    s_sub_u32 s27, s66, 4
    s_lshr_b32 s65, s27, 1
    s_and_b32 s27, s66, 1
    s_mul_i32 s27, s27, 3
    s_cmp_lt_u32 s64, 36
    s_cselect_b32 s65, 0, s65
    s_cselect_b32 s66, s66, s27
    s_lshl_b32 s63, s66, 2
    s_add_u32 s63, s63, s22
    s_mul_i32 s63, s63, 36864
    s_lshl_b32 s28, s67, 2
    s_add_u32 s28, s28, s22
    s_mul_i32 s28, s28, 36864
    s_add_u32 s28, s28, 768
    s_mul_i32 s29, s22, 12288
    s_lshl_b32 s30, s67, 7
    s_add_u32 s29, s29, s30
    s_mov_b32 s30, 49152
    s_cmp_eq_u32 s65, 1
    s_cselect_b32 s61, s28, s29
    s_cselect_b32 s26, 128, s30
    s_cselect_b32 s27, 0, 1536
    s_cselect_b32 s28, 1, 0
    s_cselect_b32 s29, 7, 2
    s_movk_i32 s30, 768
    s_cselect_b32 s30, 2304, s30
    s_add_u32 s63, s63, s27
    v_lshrrev_b32 v5, 3, v1
    v_mul_u32_u24 v6, s30, v5
    v_lshrrev_b32 v5, s28, v5
    v_and_b32 v5, s29, v5
    v_and_b32 v7, 7, v1
    v_xor_b32 v7, v7, v5
    v_lshl_add_u32 v200, v7, 4, v6
    v_xor_b32 v7, 64, v200
    s_lshl_b32 s30, s30, 3
    s_sub_u32 s30, s30, 1024
    v_add_u32 v201, s30, v7
    v_lshrrev_b32 v5, 3, v1
    v_mul_u32_u24 v6, 2304, v5
    v_lshrrev_b32 v5, 1, v5
    v_and_b32 v7, 7, v1
    v_xor_b32 v7, v7, v5
    v_lshl_add_u32 v206, v7, 4, v6
    v_xor_b32 v7, 64, v206
    v_add_u32 v207, 17408, v7
    s_lshl_b32 s68, s22, 11
    s_waitcnt lgkmcnt(0)
    s_load_dword s23, s[18:19], 0
    s_cmp_eq_u32 s65, 0
    s_cselect_b32 s36, s6, s10
    s_cselect_b32 s37, s7, s11
    s_cselect_b32 s40, s8, s12
    s_cselect_b32 s41, s9, s13
    s_mov_b32 s38, 884736
    s_cmp_eq_u32 s65, 1
    s_cselect_b32 s40, s10, s40
    s_cselect_b32 s41, s11, s41
    s_cselect_b32 s42, s38, 294912
    s_cmp_ge_u32 s64, 36
    s_cbranch_scc1 L_prod3
    s_add_u32 m0, s68, 0
    s_add_u32 s27, s63, 0
    buffer_load_dwordx4 v200, s[40:43], s61 offen lds
    buffer_load_dwordx4 v201, s[40:43], s61 offen offset:1024 lds
    s_add_u32 m0, s68, 49152
    s_add_u32 s61, s61, s26
    buffer_load_dwordx4 v206, s[36:39], s27 offen lds
    buffer_load_dwordx4 v207, s[36:39], s27 offen offset:1024 lds
    s_add_u32 m0, s68, 8192
    s_add_u32 s27, s63, 128
    buffer_load_dwordx4 v200, s[40:43], s61 offen lds
    buffer_load_dwordx4 v201, s[40:43], s61 offen offset:1024 lds
    s_add_u32 m0, s68, 57344
    s_add_u32 s61, s61, s26
    buffer_load_dwordx4 v206, s[36:39], s27 offen lds
    buffer_load_dwordx4 v207, s[36:39], s27 offen offset:1024 lds
    s_add_u32 m0, s68, 16384
    s_add_u32 s27, s63, 256
    buffer_load_dwordx4 v200, s[40:43], s61 offen lds
    buffer_load_dwordx4 v201, s[40:43], s61 offen offset:1024 lds
    s_add_u32 m0, s68, 65536
    s_add_u32 s61, s61, s26
    buffer_load_dwordx4 v206, s[36:39], s27 offen lds
    buffer_load_dwordx4 v207, s[36:39], s27 offen offset:1024 lds
    s_branch L_prod_body
L_prod3:
    s_cmp_ge_u32 s64, 60
    s_cbranch_scc1 L_prod_idle
    s_add_u32 m0, s68, 0
    s_add_u32 s27, s63, 0
    buffer_load_dwordx4 v200, s[40:43], s61 offen lds
    buffer_load_dwordx4 v201, s[40:43], s61 offen offset:1024 lds
    s_add_u32 m0, s68, 49152
    s_add_u32 s61, s61, s26
    buffer_load_dwordx4 v206, s[36:39], s27 offen lds
    buffer_load_dwordx4 v207, s[36:39], s27 offen offset:1024 lds
    s_add_u32 m0, s68, 57344
    s_add_u32 s27, s27, 147456
    buffer_load_dwordx4 v206, s[36:39], s27 offen lds
    buffer_load_dwordx4 v207, s[36:39], s27 offen offset:1024 lds
    s_add_u32 m0, s68, 65536
    s_add_u32 s27, s27, 147456
    buffer_load_dwordx4 v206, s[36:39], s27 offen lds
    buffer_load_dwordx4 v207, s[36:39], s27 offen offset:1024 lds
    s_branch L_prod3_body
L_main:
    s_mov_b32 s32, s18
    s_mov_b32 s33, s19
    s_mov_b32 s44, s14
    s_mov_b32 s45, s15
    s_mov_b32 s46, 1572864
    s_mov_b32 s47, 0x20000
    s_mov_b32 s58, 0x3f803f80
    s_getreg_b32 s24, hwreg(HW_REG_XCC_ID, 0, 3)
    v_mov_b32 v12, s58
    v_mov_b32 v13, s58
    v_mov_b32 v14, s58
    v_mov_b32 v15, s58
    v_mov_b32 v69, 0xffffff00
    v_mov_b32 v228, 0
    v_cmp_eq_u32 s[50:51], 0, v3
    v_lshrrev_b32 v4, 1, v3
    v_lshrrev_b32 v5, 3, v2
    v_cmp_eq_u32 s[48:49], v4, v5
    v_lshrrev_b32 v5, 2, v2
    v_cmp_eq_u32 s[100:101], v3, v5
    s_lshl_b32 s27, s20, 7
    s_add_u32 s27, s27, 4096
    v_and_b32 v5, 31, v1
    v_lshlrev_b32 v5, 10, v5
    v_add_u32 v230, s27, v5
    v_min_u32 v231, 11, v1
    s_mul_i32 s28, s20, 12288
    v_lshlrev_b32 v231, 7, v231
    s_bitcmp0_b32 s21, 3
    s_cselect_b32 s27, 0, 1536
    s_add_u32 s27, s27, 6390272
    s_add_u32 s27, s27, s28
    v_add_u32 v231, s27, v231
    v_min_u32 v4, 5, v1
    v_mul_u32_u24 v4, 768, v4
    s_lshl_b32 s27, s60, 7
    s_add_u32 s27, s27, s28
    s_add_u32 s27, s27, 6385664
    v_add_u32 v246, s27, v4
    v_lshrrev_b32 v4, 1, v3
    v_lshlrev_b32 v4, 12, v4
    v_and_b32 v5, 1, v3
    v_lshl_add_u32 v4, v5, 10, v4
    v_lshrrev_b32 v6, 2, v2
    v_lshl_add_u32 v4, v6, 7, v4
    v_lshrrev_b32 v6, 3, v2
    v_lshl_or_b32 v6, v5, 1, v6
    v_lshl_add_u32 v4, v6, 5, v4
    v_and_b32 v6, 3, v2
    v_lshl_add_u32 v74, v6, 3, v4
    v_xor_b32 v75, 32, v74
    v_xor_b32 v76, 64, v74
    v_xor_b32 v77, 96, v74
    v_cmp_eq_u32 s[4:5], 1, v6
    v_cmp_eq_u32 s[6:7], 2, v6
    v_cmp_eq_u32 s[8:9], 3, v6
    v_and_b32 v4, 7, v1
    v_lshl_add_u32 v4, v3, 3, v4
    v_lshlrev_b32 v204, 4, v4
    s_add_u32 s64, s64, 110592
    v_lshrrev_b32 v4, 1, v2
    v_xor_b32 v4, v4, v3
    v_lshlrev_b32 v4, 4, v4
    v_lshl_add_u32 v4, v2, 7, v4
    v_add_u32 v6, s72, v4
    v_xor_b32 v7, 64, v6
    s_mov_b32 s28, s60
    s_lshl_b32 s28, s28, 11
    v_add_u32 v8, s28, v6
    v_add_u32 v9, s28, v7
    s_lshl_b32 s71, s22, 12
    s_mul_i32 s0, s60, 49152
    s_add_u32 s0, s0, s71
    s_add_u32 s0, s0, 733184
    s_lshl_b32 s28, s60, 9
    s_add_u32 s68, s64, s28
    v_and_b32 v4, 1, v2
    v_lshlrev_b32 v4, 4, v4
    v_mov_b32 v5, 0x3f80
    v_lshlrev_b32 v4, v4, v5
    v_cndmask_b32 v4, 0, v4, s[100:101]
    v_and_b32 v5, 2, v2
    v_cmp_eq_u32 vcc, 0, v5
    v_mov_b32 v82, 0
    v_mov_b32 v83, 0
    v_cndmask_b32 v80, 0, v4, vcc
    v_cndmask_b32 v81, v4, 0, vcc
    v_mov_b32 v84, 0
    v_mov_b32 v85, 0
    v_mov_b32 v86, v80
    v_mov_b32 v87, v81
    v_add_u32 v236, 98304, v68
    v_lshlrev_b32 v4, 3, v2
    s_lshl_b32 s27, s22, 7
    s_add_u32 s27, s27, 154112
    v_add_u32 v238, s27, v4
    v_and_b32 v4, 7, v2
    v_lshrrev_b32 v5, 3, v2
    v_lshl_add_u32 v5, v3, 3, v5
    s_lshl_b32 s28, s22, 1
    v_add_u32 v5, s28, v5
    v_xor_b32 v5, v5, v4
    v_lshlrev_b32 v5, 4, v5
    v_lshl_add_u32 v5, v4, 10, v5
    v_add_u32 v237, 81920, v5
    v_xor_b32 v4, s28, v1
    v_lshlrev_b32 v4, 4, v4
    s_lshl_b32 s29, s22, 11
    s_add_u32 s29, s29, 81920
    v_add_u32 v239, s29, v4
    v_xor_b32 v240, 16, v239
    v_lshrrev_b32 v4, 3, v1
    v_lshlrev_b32 v4, 8, v4
    v_and_b32 v5, 7, v1
    v_lshl_add_u32 v241, v5, 4, v4
    s_mul_i32 s73, s22, 393216
    s_lshr_b32 s28, s25, 1
    s_mul_i32 s28, s28, 12288
    s_add_u32 s73, s73, s28
    s_and_b32 s28, s25, 1
    s_lshl_b32 s28, s28, 7
    s_add_u32 s73, s73, s28
    s_lshl_b32 s28, s60, 11
    s_add_u32 s73, s73, s28
    s_add_u32 s73, s73, 1617920
    s_add_u32 s69, s73, 196608
    s_mul_i32 s74, s25, 6
    s_add_u32 s74, s74, s60
    s_lshl_b32 s28, s74, 2
    s_lshl_b32 s74, s74, 7
    s_add_u32 s75, s74, 503808
    v_and_b32 v4, 7, v1
    v_mul_u32_u24 v4, 24576, v4
    v_and_b32 v5, -8, v1
    v_add_u32 v242, v4, v5
    v_lshlrev_b32 v243, 3, v1
    v_add_u32 v243, 154112, v243
    s_mul_i32 s28, s59, 6
    s_add_u32 s28, s28, s60
    s_lshl_b32 s28, s28, 2
    s_add_u32 s28, s28, s22
    s_bfe_u32 s29, s20, 0x10001
    s_and_b32 s30, s20, 1
    v_mul_u32_u24 v4, 43, v1
    v_lshrrev_b32 v4, 8, v4
    v_mul_u32_u24 v4, 1536, v4
    v_lshl_add_u32 v245, v1, 7, v4
    v_mul_u32_u24 v4, 86, v1
    v_lshrrev_b32 v4, 8, v4
    v_mul_u32_u24 v4, 384, v4
    v_lshl_add_u32 v5, v1, 7, v4
    s_mov_b32 s16, s10
    s_mov_b32 s17, s11
    s_cmp_ge_u32 s28, 48
    s_cbranch_scc1 L_mt_b
    s_mul_i32 s29, s29, 442368
    s_mul_i32 s28, s28, 9216
    s_add_u32 s28, s28, s29
    s_cmp_ge_u32 s20, 4
    s_cselect_b32 s29, 1536, 0
    s_add_u32 s28, s28, s29
    s_branch L_mt_e
L_mt_b:
    s_sub_u32 s28, s28, 48
    s_cmp_ge_u32 s20, 4
    s_cbranch_scc1 L_mt_c
    s_mul_i32 s30, s30, 442368
    s_mul_i32 s28, s28, 9216
    s_add_u32 s28, s28, s30
    s_add_u32 s28, s28, 768
    s_branch L_mt_e
L_mt_c:
    s_mul_i32 s30, s30, 384
    s_mul_i32 s28, s28, 6144
    s_add_u32 s28, s28, s30
    s_mov_b32 s16, s12
    s_mov_b32 s17, s13
    v_mov_b32 v245, v5
L_mt_e:
    v_add_u32 v245, s28, v245
    v_mov_b32 v220, -1
    v_mov_b32 v232, -1
    v_mov_b32 v221, -1
    v_mov_b32 v233, -1
    v_mov_b32 v222, -1
    v_mov_b32 v234, -1
    v_mov_b32 v223, -1
    v_mov_b32 v235, -1
    s_mov_b32 m0, s67
    s_add_u32 s67, s67, 16384
    buffer_load_dwordx4 v200, s[40:43], s66 offen offset:0 lds
    buffer_load_dwordx4 v201, s[40:43], s66 offen offset:1024 lds
    buffer_load_dwordx4 v202, s[40:43], s66 offen offset:2048 lds
    buffer_load_dwordx4 v203, s[40:43], s66 offen offset:3072 lds
    s_add_u32 s66, s66, 147456
    s_waitcnt lgkmcnt(0)
    s_and_b32 s27, s23, 0x78787878
    s_add_u32 s27, s27, 0x08080808
    s_and_b32 s28, s23, 0x80808080
    s_xor_b32 s23, s27, s28
    s_or_b32 s24, s24, s23
    s_lshl_b32 s27, s2, 7
    s_add_u32 s27, s27, 4096
    v_mov_b32 v4, s24
    v_mov_b32 v229, s23
    s_mov_b64 exec, 1
    buffer_store_dword v4, v228, s[32:35], s27 offen sc1
    s_mov_b64 exec, -1
    s_and_b32 s52, s23, 0xff
    s_bfe_u32 s53, s23, 0x80008
    s_bfe_u32 s54, s23, 0x80010
    s_lshr_b32 s55, s23, 24
    s_waitcnt vmcnt(17)
    ds_read_b128 v[16:19], v6 offset:0
    ds_read_b128 v[20:23], v7 offset:0
    s_mov_b32 m0, s67
    s_add_u32 s67, s67, 16384
    buffer_load_dwordx4 v200, s[40:43], s66 offen offset:0 lds
    ds_read_b128 v[24:27], v6 offset:2048
    ds_read_b128 v[28:31], v7 offset:2048
    s_waitcnt vmcnt(14)
    ds_read_b128 v[32:35], v6 offset:4096
    ds_read_b128 v[36:39], v7 offset:4096
    s_waitcnt lgkmcnt(5)
    v_mfma_f32_16x16x32_bf16 v[188:191], v[16:19], v[16:19], 0
    v_mfma_f32_16x16x32_bf16 v[184:187], v[12:15], v[16:19], 0
    buffer_load_dwordx4 v201, s[40:43], s66 offen offset:1024 lds
    ds_read_b128 v[40:43], v6 offset:6144
    s_waitcnt lgkmcnt(5)
    v_mfma_f32_16x16x32_bf16 v[188:191], v[20:23], v[20:23], v[188:191]
    v_mfma_f32_16x16x32_bf16 v[184:187], v[12:15], v[20:23], v[184:187]
    ds_read_b128 v[44:47], v7 offset:6144
    s_waitcnt lgkmcnt(5)
    v_mfma_f32_16x16x32_bf16 v[188:191], v[24:27], v[24:27], v[188:191]
    v_mfma_f32_16x16x32_bf16 v[184:187], v[12:15], v[24:27], v[184:187]
    s_waitcnt vmcnt(11)
    ds_read_b128 v[48:51], v6 offset:8192
    s_waitcnt lgkmcnt(5)
    v_mfma_f32_16x16x32_bf16 v[188:191], v[28:31], v[28:31], v[188:191]
    v_mfma_f32_16x16x32_bf16 v[184:187], v[12:15], v[28:31], v[184:187]
    ds_read_b128 v[52:55], v7 offset:8192
    s_waitcnt lgkmcnt(5)
    v_mfma_f32_16x16x32_bf16 v[188:191], v[32:35], v[32:35], v[188:191]
    v_mfma_f32_16x16x32_bf16 v[184:187], v[12:15], v[32:35], v[184:187]
    buffer_load_dwordx4 v202, s[40:43], s66 offen offset:2048 lds
    ds_read_b128 v[56:59], v6 offset:10240
    s_waitcnt lgkmcnt(5)
    v_mfma_f32_16x16x32_bf16 v[188:191], v[36:39], v[36:39], v[188:191]
    v_mfma_f32_16x16x32_bf16 v[184:187], v[12:15], v[36:39], v[184:187]
    s_waitcnt lgkmcnt(4)
    v_mfma_f32_16x16x32_bf16 v[188:191], v[40:43], v[40:43], v[188:191]
    v_mfma_f32_16x16x32_bf16 v[184:187], v[12:15], v[40:43], v[184:187]
    s_waitcnt lgkmcnt(3)
    v_mfma_f32_16x16x32_bf16 v[188:191], v[44:47], v[44:47], v[188:191]
    v_mfma_f32_16x16x32_bf16 v[184:187], v[12:15], v[44:47], v[184:187]
    ds_read_b128 v[60:63], v7 offset:10240
    ds_read_b128 v[192:195], v8
    ds_read_b128 v[196:199], v9
    s_waitcnt lgkmcnt(5)
    v_mfma_f32_16x16x32_bf16 v[188:191], v[48:51], v[48:51], v[188:191]
    v_mfma_f32_16x16x32_bf16 v[184:187], v[12:15], v[48:51], v[184:187]
    s_waitcnt lgkmcnt(4)
    v_mfma_f32_16x16x32_bf16 v[188:191], v[52:55], v[52:55], v[188:191]
    v_mfma_f32_16x16x32_bf16 v[184:187], v[12:15], v[52:55], v[184:187]
    s_waitcnt lgkmcnt(3)
    v_mfma_f32_16x16x32_bf16 v[188:191], v[56:59], v[56:59], v[188:191]
    v_mfma_f32_16x16x32_bf16 v[184:187], v[12:15], v[56:59], v[184:187]
    s_waitcnt lgkmcnt(0)
    v_mfma_f32_16x16x32_bf16 v[188:191], v[60:63], v[60:63], v[188:191]
    v_mfma_f32_16x16x32_bf16 v[184:187], v[12:15], v[60:63], v[184:187]
    s_nop 7
    v_mul_f32 v88, 0xbb2aaaab, v184
    v_mul_f32 v89, 0xbb2aaaab, v184
    v_mul_f32 v90, 0xbb2aaaab, v184
    v_mul_f32 v91, 0xbb2aaaab, v184
    v_cndmask_b32 v188, v188, v189, s[4:5]
    v_cndmask_b32 v188, v188, v190, s[6:7]
    v_mfma_f32_16x16x32_bf16 v[96:99], v[80:83], v[16:19], v[88:91]
    v_mfma_f32_16x16x32_bf16 v[100:103], v[84:87], v[16:19], v[88:91]
    v_cndmask_b32 v188, v188, v191, s[8:9]
    v_cndmask_b32 v188, 0, v188, s[100:101]
    v_mov_b32 v4, v188
    s_nop 1
    v_permlane16_swap_b32 v188, v4
    s_nop 0
    v_add_f32 v188, v188, v4
    v_mov_b32 v4, v188
    s_nop 1
    v_mfma_f32_16x16x32_bf16 v[104:107], v[80:83], v[20:23], v[88:91]
    v_mfma_f32_16x16x32_bf16 v[108:111], v[84:87], v[20:23], v[88:91]
    v_permlane32_swap_b32 v188, v4
    s_nop 0
    v_add_f32 v188, v188, v4
    v_mul_f32 v67, 0x3b2aaaab, v184
    v_mul_f32 v66, 0x3b2aaaab, v188
    v_fma_f32 v66, -v67, v67, v66
    v_max_f32 v66, 0, v66
    v_add_f32 v66, 0x3727c5ac, v66
    v_rsq_f32 v66, v66
    buffer_load_dwordx4 v203, s[40:43], s66 offen offset:3072 lds
    v_mfma_f32_16x16x32_bf16 v[112:115], v[80:83], v[24:27], v[88:91]
    v_mfma_f32_16x16x32_bf16 v[116:119], v[84:87], v[24:27], v[88:91]
    v_cvt_pk_bf16_f32 v16, v96, v97
    v_cvt_pk_bf16_f32 v17, v98, v99
    v_cvt_pk_bf16_f32 v18, v100, v101
    v_cvt_pk_bf16_f32 v19, v102, v103
    v_mfma_f32_16x16x32_bf16 v[120:123], v[80:83], v[28:31], v[88:91]
    v_mfma_f32_16x16x32_bf16 v[124:127], v[84:87], v[28:31], v[88:91]
    v_cvt_pk_bf16_f32 v20, v104, v105
    v_cvt_pk_bf16_f32 v21, v106, v107
    v_cvt_pk_bf16_f32 v22, v108, v109
    v_cvt_pk_bf16_f32 v23, v110, v111
    s_add_u32 s66, s66, 147456
    s_mov_b32 m0, s67
    s_add_u32 s67, s67, 16384
    buffer_load_dwordx4 v200, s[40:43], s66 offen offset:0 lds
    v_mfma_f32_16x16x32_bf16 v[96:99], v[80:83], v[32:35], v[88:91]
    v_mfma_f32_16x16x32_bf16 v[100:103], v[84:87], v[32:35], v[88:91]
    v_cvt_pk_bf16_f32 v24, v112, v113
    v_cvt_pk_bf16_f32 v25, v114, v115
    v_cvt_pk_bf16_f32 v26, v116, v117
    v_cvt_pk_bf16_f32 v27, v118, v119
    v_mfma_f32_16x16x32_bf16 v[104:107], v[80:83], v[36:39], v[88:91]
    v_mfma_f32_16x16x32_bf16 v[108:111], v[84:87], v[36:39], v[88:91]
    v_cvt_pk_bf16_f32 v28, v120, v121
    v_cvt_pk_bf16_f32 v29, v122, v123
    v_cvt_pk_bf16_f32 v30, v124, v125
    v_cvt_pk_bf16_f32 v31, v126, v127
    buffer_load_dwordx4 v201, s[40:43], s66 offen offset:1024 lds
    v_mfma_f32_16x16x32_bf16 v[112:115], v[80:83], v[40:43], v[88:91]
    v_mfma_f32_16x16x32_bf16 v[116:119], v[84:87], v[40:43], v[88:91]
    v_cvt_pk_bf16_f32 v32, v96, v97
    v_cvt_pk_bf16_f32 v33, v98, v99
    v_cvt_pk_bf16_f32 v34, v100, v101
    v_cvt_pk_bf16_f32 v35, v102, v103
    v_mfma_f32_16x16x32_bf16 v[120:123], v[80:83], v[44:47], v[88:91]
    v_mfma_f32_16x16x32_bf16 v[124:127], v[84:87], v[44:47], v[88:91]
    v_cvt_pk_bf16_f32 v36, v104, v105
    v_cvt_pk_bf16_f32 v37, v106, v107
    v_cvt_pk_bf16_f32 v38, v108, v109
    v_cvt_pk_bf16_f32 v39, v110, v111
    buffer_load_dwordx4 v202, s[40:43], s66 offen offset:2048 lds
    v_mfma_f32_16x16x32_bf16 v[96:99], v[80:83], v[48:51], v[88:91]
    v_mfma_f32_16x16x32_bf16 v[100:103], v[84:87], v[48:51], v[88:91]
    v_cvt_pk_bf16_f32 v40, v112, v113
    v_cvt_pk_bf16_f32 v41, v114, v115
    v_cvt_pk_bf16_f32 v42, v116, v117
    v_cvt_pk_bf16_f32 v43, v118, v119
    v_mfma_f32_16x16x32_bf16 v[104:107], v[80:83], v[52:55], v[88:91]
    v_mfma_f32_16x16x32_bf16 v[108:111], v[84:87], v[52:55], v[88:91]
    v_cvt_pk_bf16_f32 v44, v120, v121
    v_cvt_pk_bf16_f32 v45, v122, v123
    v_cvt_pk_bf16_f32 v46, v124, v125
    v_cvt_pk_bf16_f32 v47, v126, v127
    buffer_load_dwordx4 v203, s[40:43], s66 offen offset:3072 lds
    v_mfma_f32_16x16x32_bf16 v[112:115], v[80:83], v[56:59], v[88:91]
    v_mfma_f32_16x16x32_bf16 v[116:119], v[84:87], v[56:59], v[88:91]
    v_cvt_pk_bf16_f32 v48, v96, v97
    v_cvt_pk_bf16_f32 v49, v98, v99
    v_cvt_pk_bf16_f32 v50, v100, v101
    v_cvt_pk_bf16_f32 v51, v102, v103
    v_mfma_f32_16x16x32_bf16 v[120:123], v[80:83], v[60:63], v[88:91]
    v_mfma_f32_16x16x32_bf16 v[124:127], v[84:87], v[60:63], v[88:91]
    v_cvt_pk_bf16_f32 v52, v104, v105
    v_cvt_pk_bf16_f32 v53, v106, v107
    v_cvt_pk_bf16_f32 v54, v108, v109
    v_cvt_pk_bf16_f32 v55, v110, v111
    s_add_u32 s66, s66, 147456
    s_mov_b32 m0, s67
    s_add_u32 s67, s67, 16384
    buffer_load_dwordx4 v200, s[40:43], s66 offen offset:0 lds
    s_nop 1
    v_cvt_pk_bf16_f32 v56, v112, v113
    v_cvt_pk_bf16_f32 v57, v114, v115
    v_cvt_pk_bf16_f32 v58, v116, v117
    v_cvt_pk_bf16_f32 v59, v118, v119
    s_nop 1
    v_cvt_pk_bf16_f32 v60, v120, v121
    v_cvt_pk_bf16_f32 v61, v122, v123
    v_cvt_pk_bf16_f32 v62, v124, v125
    v_cvt_pk_bf16_f32 v63, v126, v127
    buffer_load_dwordx4 v201, s[40:43], s66 offen offset:1024 lds
    s_mov_b64 exec, 0xffffff
    global_load_dword v254, v245, s[16:17]
    s_mov_b64 exec, -1
    s_waitcnt vmcnt(16)
    s_barrier
    ds_read_b64_tr_b16 v[80:81], v74 offset:0
    ds_read_b64_tr_b16 v[82:83], v74 offset:512
    buffer_load_dwordx4 v202, s[40:43], s66 offen offset:2048 lds
    ds_read_b64_tr_b16 v[84:85], v75 offset:0
    ds_read_b64_tr_b16 v[86:87], v75 offset:512
    ds_read_b64_tr_b16 v[88:89], v76 offset:0
    ds_read_b64_tr_b16 v[90:91], v76 offset:512
    ds_read_b64_tr_b16 v[92:93], v77 offset:0
    ds_read_b64_tr_b16 v[94:95], v77 offset:512
    buffer_load_dwordx4 v203, s[40:43], s66 offen offset:3072 lds
    ds_read_b64_tr_b16 v[96:97], v74 offset:2048
    ds_read_b64_tr_b16 v[98:99], v74 offset:2560
    ds_read_b64_tr_b16 v[100:101], v75 offset:2048
    ds_read_b64_tr_b16 v[102:103], v75 offset:2560
    ds_read_b64_tr_b16 v[104:105], v76 offset:2048
    ds_read_b64_tr_b16 v[106:107], v76 offset:2560
    s_waitcnt lgkmcnt(12)
    v_mfma_f32_16x16x32_bf16 v[144:147], v[80:83], v[16:19], 0
    s_add_u32 s66, s66, 147456
    s_mov_b32 m0, s67
    s_add_u32 s67, s67, 16384
    buffer_load_dwordx4 v200, s[40:43], s66 offen offset:0 lds
    ds_read_b64_tr_b16 v[108:109], v77 offset:2048
    ds_read_b64_tr_b16 v[110:111], v77 offset:2560
    s_waitcnt lgkmcnt(12)
    v_mfma_f32_16x16x32_bf16 v[148:151], v[84:87], v[16:19], 0
    ds_read_b64_tr_b16 v[112:113], v74 offset:8192
    ds_read_b64_tr_b16 v[114:115], v74 offset:8704
    s_waitcnt lgkmcnt(12)
    v_mfma_f32_16x16x32_bf16 v[152:155], v[88:91], v[16:19], 0
    ds_read_b64_tr_b16 v[116:117], v75 offset:8192
    ds_read_b64_tr_b16 v[118:119], v75 offset:8704
    s_waitcnt lgkmcnt(12)
    v_mfma_f32_16x16x32_bf16 v[156:159], v[92:95], v[16:19], 0
    buffer_load_dwordx4 v201, s[40:43], s66 offen offset:1024 lds
    ds_read_b64_tr_b16 v[120:121], v76 offset:8192
    ds_read_b64_tr_b16 v[122:123], v76 offset:8704
    s_waitcnt lgkmcnt(12)
    v_mfma_f32_16x16x32_bf16 v[160:163], v[96:99], v[16:19], 0
    ds_read_b64_tr_b16 v[124:125], v77 offset:8192
    ds_read_b64_tr_b16 v[126:127], v77 offset:8704
    s_waitcnt lgkmcnt(12)
    v_mfma_f32_16x16x32_bf16 v[164:167], v[100:103], v[16:19], 0
    ds_read_b64_tr_b16 v[128:129], v74 offset:10240
    ds_read_b64_tr_b16 v[130:131], v74 offset:10752
    s_waitcnt lgkmcnt(12)
    v_mfma_f32_16x16x32_bf16 v[168:171], v[104:107], v[16:19], 0
    buffer_load_dwordx4 v202, s[40:43], s66 offen offset:2048 lds
    ds_read_b64_tr_b16 v[132:133], v75 offset:10240
    ds_read_b64_tr_b16 v[134:135], v75 offset:10752
    s_waitcnt lgkmcnt(12)
    v_mfma_f32_16x16x32_bf16 v[172:175], v[108:111], v[16:19], 0
    ds_read_b64_tr_b16 v[136:137], v76 offset:10240
    ds_read_b64_tr_b16 v[138:139], v76 offset:10752
    s_waitcnt lgkmcnt(12)
    v_mfma_f32_16x16x32_bf16 v[144:147], v[112:115], v[20:23], v[144:147]
    ds_read_b64_tr_b16 v[140:141], v77 offset:10240
    ds_read_b64_tr_b16 v[142:143], v77 offset:10752
    s_waitcnt lgkmcnt(12)
    v_mfma_f32_16x16x32_bf16 v[148:151], v[116:119], v[20:23], v[148:151]
    s_waitcnt vmcnt(17)
    s_barrier
    ds_read_b64_tr_b16 v[80:81], v74 offset:16384
    ds_read_b64_tr_b16 v[82:83], v74 offset:16896
    s_waitcnt lgkmcnt(12)
    v_mfma_f32_16x16x32_bf16 v[152:155], v[120:123], v[20:23], v[152:155]
    buffer_load_dwordx4 v203, s[40:43], s66 offen offset:3072 lds
    ds_read_b64_tr_b16 v[84:85], v75 offset:16384
    ds_read_b64_tr_b16 v[86:87], v75 offset:16896
    s_waitcnt lgkmcnt(12)
    v_mfma_f32_16x16x32_bf16 v[156:159], v[124:127], v[20:23], v[156:159]
    ds_read_b64_tr_b16 v[88:89], v76 offset:16384
    ds_read_b64_tr_b16 v[90:91], v76 offset:16896
    s_waitcnt lgkmcnt(12)
    v_mfma_f32_16x16x32_bf16 v[160:163], v[128:131], v[20:23], v[160:163]
    ds_read_b64_tr_b16 v[92:93], v77 offset:16384
    ds_read_b64_tr_b16 v[94:95], v77 offset:16896
    s_waitcnt lgkmcnt(12)
    v_mfma_f32_16x16x32_bf16 v[164:167], v[132:135], v[20:23], v[164:167]
    s_add_u32 s66, s66, 147456
    buffer_load_dword v254, v204, s[32:35], s68 offen sc1
    ds_read_b64_tr_b16 v[96:97], v74 offset:18432
    ds_read_b64_tr_b16 v[98:99], v74 offset:18944
    s_waitcnt lgkmcnt(12)
    v_mfma_f32_16x16x32_bf16 v[168:171], v[136:139], v[20:23], v[168:171]
    ds_read_b64_tr_b16 v[100:101], v75 offset:18432
    ds_read_b64_tr_b16 v[102:103], v75 offset:18944
    s_waitcnt lgkmcnt(12)
    v_mfma_f32_16x16x32_bf16 v[172:175], v[140:143], v[20:23], v[172:175]
    ds_read_b64_tr_b16 v[104:105], v76 offset:18432
    ds_read_b64_tr_b16 v[106:107], v76 offset:18944
    s_waitcnt lgkmcnt(12)
    v_mfma_f32_16x16x32_bf16 v[144:147], v[80:83], v[24:27], v[144:147]
    buffer_load_dword v254, v242, s[32:35], s75 offen sc1
    ds_read_b64_tr_b16 v[108:109], v77 offset:18432
    ds_read_b64_tr_b16 v[110:111], v77 offset:18944
    s_waitcnt lgkmcnt(12)
    v_mfma_f32_16x16x32_bf16 v[148:151], v[84:87], v[24:27], v[148:151]
    ds_read_b64_tr_b16 v[112:113], v74 offset:24576
    ds_read_b64_tr_b16 v[114:115], v74 offset:25088
    s_waitcnt lgkmcnt(12)
    v_mfma_f32_16x16x32_bf16 v[152:155], v[88:91], v[24:27], v[152:155]
    ds_read_b64_tr_b16 v[116:117], v75 offset:24576
    ds_read_b64_tr_b16 v[118:119], v75 offset:25088
    s_waitcnt lgkmcnt(12)
    v_mfma_f32_16x16x32_bf16 v[156:159], v[92:95], v[24:27], v[156:159]
    buffer_store_dwordx4 v[220:223], v241, s[32:35], s73 offen sc1
    ds_read_b64_tr_b16 v[120:121], v76 offset:24576
    ds_read_b64_tr_b16 v[122:123], v76 offset:25088
    s_waitcnt lgkmcnt(12)
    v_mfma_f32_16x16x32_bf16 v[160:163], v[96:99], v[24:27], v[160:163]
    ds_read_b64_tr_b16 v[124:125], v77 offset:24576
    ds_read_b64_tr_b16 v[126:127], v77 offset:25088
    s_waitcnt lgkmcnt(12)
    v_mfma_f32_16x16x32_bf16 v[164:167], v[100:103], v[24:27], v[164:167]
    ds_read_b64_tr_b16 v[128:129], v74 offset:26624
    ds_read_b64_tr_b16 v[130:131], v74 offset:27136
    s_waitcnt lgkmcnt(12)
    v_mfma_f32_16x16x32_bf16 v[168:171], v[104:107], v[24:27], v[168:171]
    buffer_store_dwordx4 v[220:223], v241, s[32:35], s69 offen sc1
    ds_read_b64_tr_b16 v[132:133], v75 offset:26624
    ds_read_b64_tr_b16 v[134:135], v75 offset:27136
    s_waitcnt lgkmcnt(12)
    v_mfma_f32_16x16x32_bf16 v[172:175], v[108:111], v[24:27], v[172:175]
    ds_read_b64_tr_b16 v[136:137], v76 offset:26624
    ds_read_b64_tr_b16 v[138:139], v76 offset:27136
    s_waitcnt lgkmcnt(12)
    v_mfma_f32_16x16x32_bf16 v[144:147], v[112:115], v[28:31], v[144:147]
    ds_read_b64_tr_b16 v[140:141], v77 offset:26624
    ds_read_b64_tr_b16 v[142:143], v77 offset:27136
    s_waitcnt lgkmcnt(12)
    v_mfma_f32_16x16x32_bf16 v[148:151], v[116:119], v[28:31], v[148:151]
    s_waitcnt vmcnt(17)
    s_barrier
    buffer_load_dword v11, v230, s[32:35], 0 offen sc1
    ds_read_b64_tr_b16 v[80:81], v74 offset:32768
    ds_read_b64_tr_b16 v[82:83], v74 offset:33280
    s_waitcnt lgkmcnt(12)
    v_mfma_f32_16x16x32_bf16 v[152:155], v[120:123], v[28:31], v[152:155]
    ds_read_b64_tr_b16 v[84:85], v75 offset:32768
    ds_read_b64_tr_b16 v[86:87], v75 offset:33280
    s_waitcnt lgkmcnt(12)
    v_mfma_f32_16x16x32_bf16 v[156:159], v[124:127], v[28:31], v[156:159]
    ds_read_b64_tr_b16 v[88:89], v76 offset:32768
    ds_read_b64_tr_b16 v[90:91], v76 offset:33280
    s_waitcnt lgkmcnt(12)
    v_mfma_f32_16x16x32_bf16 v[160:163], v[128:131], v[28:31], v[160:163]
    ds_read_b64_tr_b16 v[92:93], v77 offset:32768
    ds_read_b64_tr_b16 v[94:95], v77 offset:33280
    s_waitcnt lgkmcnt(12)
    v_mfma_f32_16x16x32_bf16 v[164:167], v[132:135], v[28:31], v[164:167]
    ds_read_b64_tr_b16 v[96:97], v74 offset:34816
    ds_read_b64_tr_b16 v[98:99], v74 offset:35328
    s_waitcnt lgkmcnt(12)
    v_mfma_f32_16x16x32_bf16 v[168:171], v[136:139], v[28:31], v[168:171]
    ds_read_b64_tr_b16 v[100:101], v75 offset:34816
    ds_read_b64_tr_b16 v[102:103], v75 offset:35328
    s_waitcnt lgkmcnt(12)
    v_mfma_f32_16x16x32_bf16 v[172:175], v[140:143], v[28:31], v[172:175]
    ds_read_b64_tr_b16 v[104:105], v76 offset:34816
    ds_read_b64_tr_b16 v[106:107], v76 offset:35328
    s_waitcnt lgkmcnt(12)
    v_mfma_f32_16x16x32_bf16 v[144:147], v[80:83], v[32:35], v[144:147]
    ds_read_b64_tr_b16 v[108:109], v77 offset:34816
    ds_read_b64_tr_b16 v[110:111], v77 offset:35328
    s_waitcnt lgkmcnt(12)
    v_mfma_f32_16x16x32_bf16 v[148:151], v[84:87], v[32:35], v[148:151]
    ds_read_b64_tr_b16 v[112:113], v74 offset:40960
    ds_read_b64_tr_b16 v[114:115], v74 offset:41472
    s_waitcnt lgkmcnt(12)
    v_mfma_f32_16x16x32_bf16 v[152:155], v[88:91], v[32:35], v[152:155]
    ds_read_b64_tr_b16 v[116:117], v75 offset:40960
    ds_read_b64_tr_b16 v[118:119], v75 offset:41472
    s_waitcnt lgkmcnt(12)
    v_mfma_f32_16x16x32_bf16 v[156:159], v[92:95], v[32:35], v[156:159]
    ds_read_b64_tr_b16 v[120:121], v76 offset:40960
    ds_read_b64_tr_b16 v[122:123], v76 offset:41472
    s_waitcnt lgkmcnt(12)
    v_mfma_f32_16x16x32_bf16 v[160:163], v[96:99], v[32:35], v[160:163]
    ds_read_b64_tr_b16 v[124:125], v77 offset:40960
    ds_read_b64_tr_b16 v[126:127], v77 offset:41472
    s_waitcnt lgkmcnt(12)
    v_mfma_f32_16x16x32_bf16 v[164:167], v[100:103], v[32:35], v[164:167]
    ds_read_b64_tr_b16 v[128:129], v74 offset:43008
    ds_read_b64_tr_b16 v[130:131], v74 offset:43520
    s_waitcnt lgkmcnt(12)
    v_mfma_f32_16x16x32_bf16 v[168:171], v[104:107], v[32:35], v[168:171]
    ds_read_b64_tr_b16 v[132:133], v75 offset:43008
    ds_read_b64_tr_b16 v[134:135], v75 offset:43520
    s_waitcnt lgkmcnt(12)
    v_mfma_f32_16x16x32_bf16 v[172:175], v[108:111], v[32:35], v[172:175]
    ds_read_b64_tr_b16 v[136:137], v76 offset:43008
    ds_read_b64_tr_b16 v[138:139], v76 offset:43520
    s_waitcnt lgkmcnt(12)
    v_mfma_f32_16x16x32_bf16 v[144:147], v[112:115], v[36:39], v[144:147]
    ds_read_b64_tr_b16 v[140:141], v77 offset:43008
    ds_read_b64_tr_b16 v[142:143], v77 offset:43520
    s_waitcnt lgkmcnt(12)
    v_mfma_f32_16x16x32_bf16 v[148:151], v[116:119], v[36:39], v[148:151]
    s_waitcnt vmcnt(14)
    s_barrier
    v_add_u32 v74, 49152, v74
    v_add_u32 v75, 49152, v75
    v_add_u32 v76, 49152, v76
    v_add_u32 v77, 49152, v77
    ds_read_b64_tr_b16 v[80:81], v74 offset:0
    ds_read_b64_tr_b16 v[82:83], v74 offset:512
    s_waitcnt lgkmcnt(12)
    v_mfma_f32_16x16x32_bf16 v[152:155], v[120:123], v[36:39], v[152:155]
    ds_read_b64_tr_b16 v[84:85], v75 offset:0
    ds_read_b64_tr_b16 v[86:87], v75 offset:512
    s_waitcnt lgkmcnt(12)
    v_mfma_f32_16x16x32_bf16 v[156:159], v[124:127], v[36:39], v[156:159]
    ds_read_b64_tr_b16 v[88:89], v76 offset:0
    ds_read_b64_tr_b16 v[90:91], v76 offset:512
    s_waitcnt lgkmcnt(12)
    v_mfma_f32_16x16x32_bf16 v[160:163], v[128:131], v[36:39], v[160:163]
    ds_read_b64_tr_b16 v[92:93], v77 offset:0
    ds_read_b64_tr_b16 v[94:95], v77 offset:512
    s_waitcnt lgkmcnt(12)
    v_mfma_f32_16x16x32_bf16 v[164:167], v[132:135], v[36:39], v[164:167]
    ds_read_b64_tr_b16 v[96:97], v74 offset:2048
    ds_read_b64_tr_b16 v[98:99], v74 offset:2560
    s_waitcnt lgkmcnt(12)
    v_mfma_f32_16x16x32_bf16 v[168:171], v[136:139], v[36:39], v[168:171]
    ds_read_b64_tr_b16 v[100:101], v75 offset:2048
    ds_read_b64_tr_b16 v[102:103], v75 offset:2560
    s_waitcnt lgkmcnt(12)
    v_mfma_f32_16x16x32_bf16 v[172:175], v[140:143], v[36:39], v[172:175]
    ds_read_b64_tr_b16 v[104:105], v76 offset:2048
    ds_read_b64_tr_b16 v[106:107], v76 offset:2560
    s_waitcnt lgkmcnt(12)
    v_mfma_f32_16x16x32_bf16 v[144:147], v[80:83], v[40:43], v[144:147]
    ds_read_b64_tr_b16 v[108:109], v77 offset:2048
    ds_read_b64_tr_b16 v[110:111], v77 offset:2560
    s_waitcnt lgkmcnt(12)
    v_mfma_f32_16x16x32_bf16 v[148:151], v[84:87], v[40:43], v[148:151]
    ds_read_b64_tr_b16 v[112:113], v74 offset:8192
    ds_read_b64_tr_b16 v[114:115], v74 offset:8704
    s_waitcnt lgkmcnt(12)
    v_mfma_f32_16x16x32_bf16 v[152:155], v[88:91], v[40:43], v[152:155]
    ds_read_b64_tr_b16 v[116:117], v75 offset:8192
    ds_read_b64_tr_b16 v[118:119], v75 offset:8704
    s_waitcnt lgkmcnt(12)
    v_mfma_f32_16x16x32_bf16 v[156:159], v[92:95], v[40:43], v[156:159]
    ds_read_b64_tr_b16 v[120:121], v76 offset:8192
    ds_read_b64_tr_b16 v[122:123], v76 offset:8704
    s_waitcnt lgkmcnt(12)
    v_mfma_f32_16x16x32_bf16 v[160:163], v[96:99], v[40:43], v[160:163]
    ds_read_b64_tr_b16 v[124:125], v77 offset:8192
    ds_read_b64_tr_b16 v[126:127], v77 offset:8704
    s_waitcnt lgkmcnt(12)
    v_mfma_f32_16x16x32_bf16 v[164:167], v[100:103], v[40:43], v[164:167]
    ds_read_b64_tr_b16 v[128:129], v74 offset:10240
    ds_read_b64_tr_b16 v[130:131], v74 offset:10752
    s_waitcnt lgkmcnt(12)
    v_mfma_f32_16x16x32_bf16 v[168:171], v[104:107], v[40:43], v[168:171]
    ds_read_b64_tr_b16 v[132:133], v75 offset:10240
    ds_read_b64_tr_b16 v[134:135], v75 offset:10752
    s_waitcnt lgkmcnt(12)
    v_mfma_f32_16x16x32_bf16 v[172:175], v[108:111], v[40:43], v[172:175]
    ds_read_b64_tr_b16 v[136:137], v76 offset:10240
    ds_read_b64_tr_b16 v[138:139], v76 offset:10752
    s_waitcnt lgkmcnt(12)
    v_mfma_f32_16x16x32_bf16 v[144:147], v[112:115], v[44:47], v[144:147]
    ds_read_b64_tr_b16 v[140:141], v77 offset:10240
    ds_read_b64_tr_b16 v[142:143], v77 offset:10752
    s_waitcnt lgkmcnt(12)
    v_mfma_f32_16x16x32_bf16 v[148:151], v[116:119], v[44:47], v[148:151]
    s_waitcnt vmcnt(9)
    s_barrier
    ds_read_b64_tr_b16 v[80:81], v74 offset:16384
    ds_read_b64_tr_b16 v[82:83], v74 offset:16896
    s_waitcnt lgkmcnt(12)
    v_mfma_f32_16x16x32_bf16 v[152:155], v[120:123], v[44:47], v[152:155]
    ds_read_b64_tr_b16 v[84:85], v75 offset:16384
    ds_read_b64_tr_b16 v[86:87], v75 offset:16896
    s_waitcnt lgkmcnt(12)
    v_mfma_f32_16x16x32_bf16 v[156:159], v[124:127], v[44:47], v[156:159]
    ds_read_b64_tr_b16 v[88:89], v76 offset:16384
    ds_read_b64_tr_b16 v[90:91], v76 offset:16896
    s_waitcnt lgkmcnt(12)
    v_mfma_f32_16x16x32_bf16 v[160:163], v[128:131], v[44:47], v[160:163]
    ds_read_b64_tr_b16 v[92:93], v77 offset:16384
    ds_read_b64_tr_b16 v[94:95], v77 offset:16896
    s_waitcnt lgkmcnt(12)
    v_mfma_f32_16x16x32_bf16 v[164:167], v[132:135], v[44:47], v[164:167]
    ds_read_b64_tr_b16 v[96:97], v74 offset:18432
    ds_read_b64_tr_b16 v[98:99], v74 offset:18944
    s_waitcnt lgkmcnt(12)
    v_mfma_f32_16x16x32_bf16 v[168:171], v[136:139], v[44:47], v[168:171]
    ds_read_b64_tr_b16 v[100:101], v75 offset:18432
    ds_read_b64_tr_b16 v[102:103], v75 offset:18944
    s_waitcnt lgkmcnt(12)
    v_mfma_f32_16x16x32_bf16 v[172:175], v[140:143], v[44:47], v[172:175]
    ds_read_b64_tr_b16 v[104:105], v76 offset:18432
    ds_read_b64_tr_b16 v[106:107], v76 offset:18944
    s_waitcnt lgkmcnt(12)
    v_mfma_f32_16x16x32_bf16 v[144:147], v[80:83], v[48:51], v[144:147]
    ds_read_b64_tr_b16 v[108:109], v77 offset:18432
    ds_read_b64_tr_b16 v[110:111], v77 offset:18944
    s_waitcnt lgkmcnt(12)
    v_mfma_f32_16x16x32_bf16 v[148:151], v[84:87], v[48:51], v[148:151]
    ds_read_b64_tr_b16 v[112:113], v74 offset:24576
    ds_read_b64_tr_b16 v[114:115], v74 offset:25088
    s_waitcnt lgkmcnt(12)
    v_mfma_f32_16x16x32_bf16 v[152:155], v[88:91], v[48:51], v[152:155]
    ds_read_b64_tr_b16 v[116:117], v75 offset:24576
    ds_read_b64_tr_b16 v[118:119], v75 offset:25088
    s_waitcnt lgkmcnt(12)
    v_mfma_f32_16x16x32_bf16 v[156:159], v[92:95], v[48:51], v[156:159]
    ds_read_b64_tr_b16 v[120:121], v76 offset:24576
    ds_read_b64_tr_b16 v[122:123], v76 offset:25088
    s_waitcnt lgkmcnt(12)
    v_mfma_f32_16x16x32_bf16 v[160:163], v[96:99], v[48:51], v[160:163]
    ds_read_b64_tr_b16 v[124:125], v77 offset:24576
    ds_read_b64_tr_b16 v[126:127], v77 offset:25088
    s_waitcnt lgkmcnt(12)
    v_mfma_f32_16x16x32_bf16 v[164:167], v[100:103], v[48:51], v[164:167]
    ds_read_b64_tr_b16 v[128:129], v74 offset:26624
    ds_read_b64_tr_b16 v[130:131], v74 offset:27136
    s_waitcnt lgkmcnt(12)
    v_mfma_f32_16x16x32_bf16 v[168:171], v[104:107], v[48:51], v[168:171]
    ds_read_b64_tr_b16 v[132:133], v75 offset:26624
    ds_read_b64_tr_b16 v[134:135], v75 offset:27136
    s_waitcnt lgkmcnt(12)
    v_mfma_f32_16x16x32_bf16 v[172:175], v[108:111], v[48:51], v[172:175]
    ds_read_b64_tr_b16 v[136:137], v76 offset:26624
    ds_read_b64_tr_b16 v[138:139], v76 offset:27136
    s_waitcnt lgkmcnt(12)
    v_mfma_f32_16x16x32_bf16 v[144:147], v[112:115], v[52:55], v[144:147]
    ds_read_b64_tr_b16 v[140:141], v77 offset:26624
    ds_read_b64_tr_b16 v[142:143], v77 offset:27136
    s_waitcnt lgkmcnt(12)
    v_mfma_f32_16x16x32_bf16 v[148:151], v[116:119], v[52:55], v[148:151]
    s_waitcnt vmcnt(5)
    s_barrier
    ds_read_b64_tr_b16 v[80:81], v74 offset:32768
    ds_read_b64_tr_b16 v[82:83], v74 offset:33280
    s_waitcnt lgkmcnt(12)
    v_mfma_f32_16x16x32_bf16 v[152:155], v[120:123], v[52:55], v[152:155]
    ds_read_b64_tr_b16 v[84:85], v75 offset:32768
    ds_read_b64_tr_b16 v[86:87], v75 offset:33280
    s_waitcnt lgkmcnt(12)
    v_mfma_f32_16x16x32_bf16 v[156:159], v[124:127], v[52:55], v[156:159]
    ds_read_b64_tr_b16 v[88:89], v76 offset:32768
    ds_read_b64_tr_b16 v[90:91], v76 offset:33280
    s_waitcnt lgkmcnt(12)
    v_mfma_f32_16x16x32_bf16 v[160:163], v[128:131], v[52:55], v[160:163]
    ds_read_b64_tr_b16 v[92:93], v77 offset:32768
    ds_read_b64_tr_b16 v[94:95], v77 offset:33280
    s_waitcnt lgkmcnt(12)
    v_mfma_f32_16x16x32_bf16 v[164:167], v[132:135], v[52:55], v[164:167]
    ds_read_b64_tr_b16 v[96:97], v74 offset:34816
    ds_read_b64_tr_b16 v[98:99], v74 offset:35328
    s_waitcnt lgkmcnt(12)
    v_mfma_f32_16x16x32_bf16 v[168:171], v[136:139], v[52:55], v[168:171]
    ds_read_b64_tr_b16 v[100:101], v75 offset:34816
    ds_read_b64_tr_b16 v[102:103], v75 offset:35328
    s_waitcnt lgkmcnt(12)
    v_mfma_f32_16x16x32_bf16 v[172:175], v[140:143], v[52:55], v[172:175]
    s_waitcnt vmcnt(0)
    buffer_load_dword v9, v246, s[32:35], 0 offen sc1
    v_and_b32 v10, -8, v11
    v_cmp_ne_u32 vcc, s23, v10
    s_mov_b32 s62, vcc_lo
    v_cmp_ne_u32 vcc, s24, v11
    s_mov_b32 s61, vcc_lo
    ds_read_b64_tr_b16 v[104:105], v76 offset:34816
    ds_read_b64_tr_b16 v[106:107], v76 offset:35328
    s_waitcnt lgkmcnt(12)
    v_mfma_f32_16x16x32_bf16 v[144:147], v[80:83], v[56:59], v[144:147]
    ds_read_b64_tr_b16 v[108:109], v77 offset:34816
    ds_read_b64_tr_b16 v[110:111], v77 offset:35328
    s_waitcnt lgkmcnt(12)
    v_mfma_f32_16x16x32_bf16 v[148:151], v[84:87], v[56:59], v[148:151]
    ds_read_b64_tr_b16 v[112:113], v74 offset:40960
    ds_read_b64_tr_b16 v[114:115], v74 offset:41472
    s_waitcnt lgkmcnt(12)
    v_mfma_f32_16x16x32_bf16 v[152:155], v[88:91], v[56:59], v[152:155]
    ds_read_b64_tr_b16 v[116:117], v75 offset:40960
    ds_read_b64_tr_b16 v[118:119], v75 offset:41472
    s_waitcnt lgkmcnt(12)
    v_mfma_f32_16x16x32_bf16 v[156:159], v[92:95], v[56:59], v[156:159]
    ds_read_b64_tr_b16 v[120:121], v76 offset:40960
    ds_read_b64_tr_b16 v[122:123], v76 offset:41472
    s_waitcnt lgkmcnt(12)
    v_mfma_f32_16x16x32_bf16 v[160:163], v[96:99], v[56:59], v[160:163]
    ds_read_b64_tr_b16 v[124:125], v77 offset:40960
    ds_read_b64_tr_b16 v[126:127], v77 offset:41472
    s_waitcnt lgkmcnt(12)
    v_mfma_f32_16x16x32_bf16 v[164:167], v[100:103], v[56:59], v[164:167]
    ds_read_b64_tr_b16 v[128:129], v74 offset:43008
    ds_read_b64_tr_b16 v[130:131], v74 offset:43520
    s_waitcnt lgkmcnt(12)
    v_mfma_f32_16x16x32_bf16 v[168:171], v[104:107], v[56:59], v[168:171]
    ds_read_b64_tr_b16 v[132:133], v75 offset:43008
    ds_read_b64_tr_b16 v[134:135], v75 offset:43520
    s_waitcnt lgkmcnt(12)
    v_mfma_f32_16x16x32_bf16 v[172:175], v[108:111], v[56:59], v[172:175]
    ds_read_b64_tr_b16 v[136:137], v76 offset:43008
    ds_read_b64_tr_b16 v[138:139], v76 offset:43520
    s_waitcnt lgkmcnt(12)
    v_mfma_f32_16x16x32_bf16 v[144:147], v[112:115], v[60:63], v[144:147]
    ds_read_b64_tr_b16 v[140:141], v77 offset:43008
    ds_read_b64_tr_b16 v[142:143], v77 offset:43520
    s_waitcnt lgkmcnt(12)
    v_mfma_f32_16x16x32_bf16 v[148:151], v[116:119], v[60:63], v[148:151]
    s_waitcnt lgkmcnt(10)
    v_mfma_f32_16x16x32_bf16 v[152:155], v[120:123], v[60:63], v[152:155]
    s_waitcnt lgkmcnt(8)
    v_mfma_f32_16x16x32_bf16 v[156:159], v[124:127], v[60:63], v[156:159]
    s_waitcnt lgkmcnt(6)
    v_mfma_f32_16x16x32_bf16 v[160:163], v[128:131], v[60:63], v[160:163]
    s_waitcnt lgkmcnt(4)
    v_mfma_f32_16x16x32_bf16 v[164:167], v[132:135], v[60:63], v[164:167]
    s_waitcnt lgkmcnt(2)
    v_mfma_f32_16x16x32_bf16 v[168:171], v[136:139], v[60:63], v[168:171]
    s_waitcnt lgkmcnt(0)
    v_mfma_f32_16x16x32_bf16 v[172:175], v[140:143], v[60:63], v[172:175]
    v_cvt_pk_bf16_f32 v176, v144, v145
    v_cvt_pk_bf16_f32 v177, v146, v147
    v_cvt_pk_bf16_f32 v178, v148, v149
    v_cvt_pk_bf16_f32 v179, v150, v151
    v_cvt_pk_bf16_f32 v180, v152, v153
    v_cvt_pk_bf16_f32 v181, v154, v155
    v_cvt_pk_bf16_f32 v182, v156, v157
    v_cvt_pk_bf16_f32 v183, v158, v159
    v_cvt_pk_bf16_f32 v184, v160, v161
    v_cvt_pk_bf16_f32 v185, v162, v163
    v_cvt_pk_bf16_f32 v186, v164, v165
    v_cvt_pk_bf16_f32 v187, v166, v167
    v_cvt_pk_bf16_f32 v188, v168, v169
    v_cvt_pk_bf16_f32 v189, v170, v171
    v_cvt_pk_bf16_f32 v190, v172, v173
    v_cvt_pk_bf16_f32 v191, v174, v175
    s_nop 0
    v_mfma_f32_16x16x32_bf16 v[112:115], v[184:187], v[176:179], 0
    v_mfma_f32_16x16x32_bf16 v[112:115], v[188:191], v[180:183], v[112:115]
    s_cmp_eq_u32 s62, 0
    s_cbranch_scc1 L_xcc_ok_2
    s_mov_b32 s31, 40000
L_xcc_1:
    buffer_load_dword v11, v230, s[32:35], 0 offen sc1
    s_waitcnt vmcnt(0)
    v_and_b32 v10, -8, v11
    v_cmp_ne_u32 vcc, s23, v10
    s_mov_b32 s62, vcc_lo
    v_cmp_ne_u32 vcc, s24, v11
    s_mov_b32 s61, vcc_lo
    s_cmp_eq_u32 s62, 0
    s_cbranch_scc1 L_xcc_ok_2
    s_sub_u32 s31, s31, 1
    s_cbranch_scc0 L_xcc_1
L_xcc_ok_2:
    s_nop 5
    v_bfi_b32 v112, v69, v112, s52
    v_bfi_b32 v113, v69, v113, s53
    v_bfi_b32 v114, v69, v114, s54
    v_bfi_b32 v115, v69, v115, s55
    s_mov_b64 exec, s[48:49]
    s_cmp_lg_u32 s61, 0
    s_cbranch_scc1 L_slow_3
    buffer_store_dwordx4 v[112:115], v204, s[32:35], s68 offen
    s_branch L_join_4
L_slow_3:
    buffer_store_dwordx4 v[112:115], v204, s[32:35], s68 offen sc1
L_join_4:
    s_mov_b64 exec, -1
    s_waitcnt vmcnt(1)
    v_cmp_ne_u32 vcc, s23, v9
    s_cbranch_vccz L_wvo_go
    v_lshlrev_b32 v4, 4, v3
    ds_bpermute_b32 v208, v4, v66 offset:0
    ds_bpermute_b32 v209, v4, v66 offset:4
    ds_bpermute_b32 v210, v4, v66 offset:8
    ds_bpermute_b32 v211, v4, v66 offset:12
    v_lshlrev_b32 v164, 16, v192
    v_and_b32 v165, 0xffff0000, v192
    v_lshlrev_b32 v166, 16, v193
    v_and_b32 v167, 0xffff0000, v193
    v_lshlrev_b32 v168, 16, v194
    v_and_b32 v169, 0xffff0000, v194
    v_lshlrev_b32 v170, 16, v195
    v_and_b32 v171, 0xffff0000, v195
    v_lshlrev_b32 v172, 16, v196
    v_and_b32 v173, 0xffff0000, v196
    v_lshlrev_b32 v174, 16, v197
    v_and_b32 v175, 0xffff0000, v197
    v_lshlrev_b32 v176, 16, v198
    v_and_b32 v177, 0xffff0000, v198
    v_lshlrev_b32 v178, 16, v199
    v_and_b32 v179, 0xffff0000, v199
    v_mul_f32 v5, 0x3d96c740, v66
    s_waitcnt lgkmcnt(0)
    v_mul_f32 v212, v5, v208
    v_mul_f32 v213, v5, v209
    v_mul_f32 v214, v5, v210
    v_mul_f32 v215, v5, v211
    s_lshr_b32 s74, s21, 4
    s_lshl_b32 s74, s74, 1
    s_and_b32 s28, s21, 15
    s_mul_i32 s29, s28, 43
    s_lshr_b32 s29, s29, 7
    s_mul_i32 s29, s29, 3
    s_sub_u32 s26, s28, s29
    s_mul_i32 s26, s26, 0
    s_lshl_b32 s28, s26, 10
    v_add_u32 v71, s28, v68
    s_add_u32 s28, s28, 4096
    s_cmp_eq_u32 s28, 12288
    s_cselect_b32 s28, 0, s28
    buffer_load_dword v9, v246, s[32:35], 0 offen sc1
    v_add_u32 v79, s28, v68
    s_add_u32 s28, s28, 4096
    s_cmp_eq_u32 s28, 12288
    s_cselect_b32 s28, 0, s28
    v_add_u32 v78, s28, v68
    s_mul_i32 s28, s22, 3
    s_add_u32 s28, s28, 12
    s_sub_u32 s26, s28, s26
    v_add_u32 v216, 4096, v68
    v_lshlrev_b32 v73, 3, v1
    v_xor_b32 v4, s74, v3
    v_lshrrev_b32 v5, 3, v2
    v_lshl_add_u32 v5, v4, 1, v5
    v_mul_u32_u24 v5, 768, v5
    v_and_b32 v4, 7, v2
    v_lshl_add_u32 v206, v4, 3, v5
    s_mul_i32 s14, s20, 24576
    s_mul_i32 s28, s22, 6144
    s_add_u32 s14, s14, s28
    s_add_u32 s14, s14, 503808
    s_mul_i32 s28, s22, 768
    s_add_u32 s28, s28, 151040
    v_lshlrev_b32 v4, 2, v1
    v_add_u32 v217, s28, v4
    v_lshlrev_b32 v244, 3, v2
    v_lshlrev_b32 v218, 4, v3
    v_add_u32 v219, s28, v218
    s_lshl_b32 s30, s20, 2
    s_add_u32 s30, s30, s22
    s_mul_i32 s30, s30, 49152
    s_add_u32 s30, s30, 1617920
    s_mul_i32 s28, s74, 12288
    s_add_u32 s76, s30, s28
    s_add_u32 s77, s76, 12288
    s_sub_u32 s78, s30, s28
    s_add_u32 s78, s78, 24576
    s_add_u32 s79, s78, 12288
    s_bfe_u32 s28, s21, 0x20002
    s_sub_u32 s81, s28, s22
    s_mul_i32 s81, s81, 49152
    s_add_u32 s81, s81, s76
    s_and_b32 s28, s22, 1
    s_mul_i32 s28, s28, 12288
    s_add_u32 s81, s81, s28
    s_and_b32 s28, s21, 3
    s_mul_i32 s28, s28, 3072
    s_add_u32 s81, s81, s28
    s_lshr_b32 s28, s22, 1
    s_lshl_b32 s28, s28, 10
    s_add_u32 s80, s28, s81
    s_lshl_b32 s19, s2, 7
    s_lshl_b32 s28, s22, 2
    s_add_u32 s19, s19, s28
    s_add_u32 s19, s19, 77824
    s_bfe_u32 s30, s21, 0x30001
    s_mul_i32 s66, s30, 73728
    s_mul_i32 s28, s22, 18432
    s_add_u32 s66, s66, s28
    s_add_u32 s66, s66, 1028096
    s_mul_i32 s15, s30, 3072
    s_add_u32 s15, s15, 6336512
    s_and_b32 s29, s21, 1
    s_lshl_b32 s28, s29, 10
    s_add_u32 s67, s66, s28
    s_lshl_b32 s28, s29, 12
    s_add_u32 s66, s66, s28
    s_lshl_b32 s28, s29, 9
    s_add_u32 s16, s15, s28
    s_lshl_b32 s28, s29, 11
    s_add_u32 s15, s15, s28
    s_lshl_b32 s18, s20, 2
    s_add_u32 s18, s18, s74
    s_lshl_b32 s18, s18, 1
    s_add_u32 s18, s18, s22
    s_mul_i32 s3, s18, 24576
    s_mul_i32 s28, s30, 3072
    s_add_u32 s3, s3, s28
    s_add_u32 s3, s3, 3190784
    s_lshl_b32 s28, s29, 3
    s_add_u32 s17, s3, s28
    s_add_u32 s17, s17, 1024
    s_lshl_b32 s28, s29, 11
    s_add_u32 s3, s3, s28
    s_lshl_b32 s18, s18, 10
    s_lshl_b32 s28, s30, 7
    s_add_u32 s18, s18, s28
    s_lshl_b32 s28, s29, 2
    s_add_u32 s18, s18, s28
    s_add_u32 s18, s18, 6483968
    s_bitcmp0_b32 s21, 3
    s_cbranch_scc1 L_p2s_4
    s_lshl_b32 s3, s20, 2
    s_add_u32 s3, s3, s30
    s_sub_u32 s3, s3, 4
    s_mul_i32 s3, s3, 49152
    s_lshl_b32 s28, s22, 2
    s_add_u32 s28, s28, s74
    s_mul_i32 s28, s28, 3072
    s_add_u32 s3, s3, s28
    s_add_u32 s3, s3, 4763648
    s_lshl_b32 s28, s29, 10
    s_add_u32 s17, s3, s28
    s_lshl_b32 s28, s29, 12
    s_add_u32 s3, s3, s28
L_p2s_4:
    buffer_load_dwordx4 v[180:183], v204, s[32:35], s64 offen offset:0 sc1
    buffer_load_dwordx4 v[184:187], v204, s[32:35], s64 offen offset:512 sc1
    buffer_load_dwordx4 v[188:191], v204, s[32:35], s64 offen offset:1024 sc1
    buffer_load_dwordx4 v[220:223], v204, s[32:35], s64 offen offset:1536 sc1
    buffer_load_dwordx4 v[224:227], v204, s[32:35], s64 offen offset:2048 sc1
    buffer_load_dwordx4 v[248:251], v204, s[32:35], s64 offen offset:2560 sc1
    s_waitcnt vmcnt(6)
    v_cmp_ne_u32 vcc, s23, v9
    s_cbranch_vccz L_wvo_l2
    s_mov_b32 s31, 40000
L_wvo_6:
    buffer_load_dword v11, v246, s[32:35], 0 offen sc1
    s_waitcnt vmcnt(0)
    v_cmp_ne_u32 vcc, s23, v11
    s_cbranch_vccz L_wvo_ok_7
    s_sub_u32 s31, s31, 1
    s_cbranch_scc0 L_wvo_6
L_wvo_ok_7:
L_wvo_l2:
    s_add_u32 m0, s71, 98304
    s_add_u32 s28, s0, 0
    buffer_load_dwordx4 v68, s[32:35], s28 offen offset:0 sc1 lds
    buffer_load_dwordx4 v68, s[32:35], s28 offen offset:1024 sc1 lds
    buffer_load_dwordx4 v68, s[32:35], s28 offen offset:2048 sc1 lds
    buffer_load_dwordx4 v68, s[32:35], s28 offen offset:3072 sc1 lds
    s_add_u32 m0, s71, 114688
    s_add_u32 s28, s0, 16384
    buffer_load_dwordx4 v68, s[32:35], s28 offen offset:0 sc1 lds
    buffer_load_dwordx4 v68, s[32:35], s28 offen offset:1024 sc1 lds
    buffer_load_dwordx4 v68, s[32:35], s28 offen offset:2048 sc1 lds
    buffer_load_dwordx4 v68, s[32:35], s28 offen offset:3072 sc1 lds
    s_add_u32 m0, s71, 131072
    s_add_u32 s28, s0, 32768
    buffer_load_dwordx4 v68, s[32:35], s28 offen offset:0 sc1 lds
    buffer_load_dwordx4 v68, s[32:35], s28 offen offset:1024 sc1 lds
    buffer_load_dwordx4 v68, s[32:35], s28 offen offset:2048 sc1 lds
    buffer_load_dwordx4 v68, s[32:35], s28 offen offset:3072 sc1 lds
    s_waitcnt vmcnt(12)
    v_xor_b32 v180, s52, v180
    v_xor_b32 v181, s53, v181
    v_xor_b32 v182, s54, v182
    v_xor_b32 v183, s55, v183
    v_or_b32 v6, v180, v181
    v_or3_b32 v6, v6, v182, v183
    v_xor_b32 v184, s52, v184
    v_xor_b32 v185, s53, v185
    v_xor_b32 v186, s54, v186
    v_xor_b32 v187, s55, v187
    v_or3_b32 v6, v6, v184, v185
    v_or3_b32 v6, v6, v186, v187
    v_xor_b32 v188, s52, v188
    v_xor_b32 v189, s53, v189
    v_xor_b32 v190, s54, v190
    v_xor_b32 v191, s55, v191
    v_or3_b32 v6, v6, v188, v189
    v_or3_b32 v6, v6, v190, v191
    v_xor_b32 v220, s52, v220
    v_xor_b32 v221, s53, v221
    v_xor_b32 v222, s54, v222
    v_xor_b32 v223, s55, v223
    v_or3_b32 v6, v6, v220, v221
    v_or3_b32 v6, v6, v222, v223
    v_xor_b32 v224, s52, v224
    v_xor_b32 v225, s53, v225
    v_xor_b32 v226, s54, v226
    v_xor_b32 v227, s55, v227
    v_or3_b32 v6, v6, v224, v225
    v_or3_b32 v6, v6, v226, v227
    v_xor_b32 v248, s52, v248
    v_xor_b32 v249, s53, v249
    v_xor_b32 v250, s54, v250
    v_xor_b32 v251, s55, v251
    v_or3_b32 v6, v6, v248, v249
    v_or3_b32 v6, v6, v250, v251
    v_and_b32 v6, 0xff, v6
    v_cmp_ne_u32 vcc, 0, v6
    s_or_b32 s1, vcc_lo, vcc_hi
    s_cbranch_scc1 L_wvo_on
    v_pk_add_f32 v[184:185], v[184:185], v[180:181]
    v_pk_add_f32 v[186:187], v[186:187], v[182:183]
    v_pk_add_f32 v[220:221], v[220:221], v[188:189]
    v_pk_add_f32 v[222:223], v[222:223], v[190:191]
    v_pk_add_f32 v[248:249], v[248:249], v[224:225]
    v_pk_add_f32 v[250:251], v[250:251], v[226:227]
    v_pk_add_f32 v[220:221], v[220:221], v[184:185]
    v_pk_add_f32 v[222:223], v[222:223], v[186:187]
    v_pk_add_f32 v[248:249], v[248:249], v[220:221]
    v_pk_add_f32 v[250:251], v[250:251], v[222:223]
    v_mul_f32 v248, v248, v212
    v_mul_f32 v249, v249, v213
    v_mul_f32 v250, v250, v214
    v_mul_f32 v251, v251, v215
    v_max3_f32 v4, v248, v249, v250
    v_max_f32 v4, v4, v251
    v_mov_b32 v5, v4
    s_nop 1
    v_permlane16_swap_b32 v4, v5
    s_nop 0
    v_max_f32 v4, v4, v5
    v_sub_f32 v248, v248, v4
    v_sub_f32 v249, v249, v4
    v_sub_f32 v250, v250, v4
    v_sub_f32 v251, v251, v4
    v_exp_f32 v248, v248
    v_exp_f32 v249, v249
    v_exp_f32 v250, v250
    v_exp_f32 v251, v251
    s_nop 0
    v_add_f32 v4, v248, v249
    v_add_f32 v5, v250, v251
    v_add_f32 v4, v4, v5
    v_mov_b32 v5, v4
    v_mul_f32 v248, v248, v208
    v_mul_f32 v249, v249, v209
    v_permlane16_swap_b32 v4, v5
    v_mul_f32 v250, v250, v210
    v_add_f32 v4, v4, v5
    v_rcp_f32 v4, v4
    v_mul_f32 v251, v251, v211
    v_cndmask_b32 v4, 0, v4, s[48:49]
    v_mul_f32 v248, v248, v4
    v_mul_f32 v249, v249, v4
    v_mul_f32 v250, v250, v4
    v_mul_f32 v251, v251, v4
    v_cvt_pk_bf16_f32 v200, v248, v249
    v_cvt_pk_bf16_f32 v201, v250, v251
    s_branch L_wvo_on
L_wvo_go:
    s_add_u32 m0, s71, 98304
    s_add_u32 s28, s0, 0
    buffer_load_dwordx4 v68, s[32:35], s28 offen offset:0 sc1 lds
    buffer_load_dwordx4 v68, s[32:35], s28 offen offset:1024 sc1 lds
    buffer_load_dwordx4 v68, s[32:35], s28 offen offset:2048 sc1 lds
    buffer_load_dwordx4 v68, s[32:35], s28 offen offset:3072 sc1 lds
    s_add_u32 m0, s71, 114688
    s_add_u32 s28, s0, 16384
    buffer_load_dwordx4 v68, s[32:35], s28 offen offset:0 sc1 lds
    buffer_load_dwordx4 v68, s[32:35], s28 offen offset:1024 sc1 lds
    buffer_load_dwordx4 v68, s[32:35], s28 offen offset:2048 sc1 lds
    buffer_load_dwordx4 v68, s[32:35], s28 offen offset:3072 sc1 lds
    s_add_u32 m0, s71, 131072
    s_add_u32 s28, s0, 32768
    buffer_load_dwordx4 v68, s[32:35], s28 offen offset:0 sc1 lds
    buffer_load_dwordx4 v68, s[32:35], s28 offen offset:1024 sc1 lds
    buffer_load_dwordx4 v68, s[32:35], s28 offen offset:2048 sc1 lds
    buffer_load_dwordx4 v68, s[32:35], s28 offen offset:3072 sc1 lds
    v_lshlrev_b32 v4, 4, v3
    ds_bpermute_b32 v208, v4, v66 offset:0
    ds_bpermute_b32 v209, v4, v66 offset:4
    ds_bpermute_b32 v210, v4, v66 offset:8
    ds_bpermute_b32 v211, v4, v66 offset:12
    v_lshlrev_b32 v164, 16, v192
    v_and_b32 v165, 0xffff0000, v192
    v_lshlrev_b32 v166, 16, v193
    v_and_b32 v167, 0xffff0000, v193
    v_lshlrev_b32 v168, 16, v194
    v_and_b32 v169, 0xffff0000, v194
    v_lshlrev_b32 v170, 16, v195
    v_and_b32 v171, 0xffff0000, v195
    v_lshlrev_b32 v172, 16, v196
    v_and_b32 v173, 0xffff0000, v196
    v_lshlrev_b32 v174, 16, v197
    v_and_b32 v175, 0xffff0000, v197
    v_lshlrev_b32 v176, 16, v198
    v_and_b32 v177, 0xffff0000, v198
    v_lshlrev_b32 v178, 16, v199
    v_and_b32 v179, 0xffff0000, v199
    v_mul_f32 v5, 0x3d96c740, v66
    s_waitcnt lgkmcnt(0)
    v_mul_f32 v212, v5, v208
    v_mul_f32 v213, v5, v209
    v_mul_f32 v214, v5, v210
    v_mul_f32 v215, v5, v211
    s_lshr_b32 s74, s21, 4
    s_lshl_b32 s74, s74, 1
    s_and_b32 s28, s21, 15
    s_mul_i32 s29, s28, 43
    s_lshr_b32 s29, s29, 7
    s_mul_i32 s29, s29, 3
    s_sub_u32 s26, s28, s29
    s_mul_i32 s26, s26, 0
    s_lshl_b32 s28, s26, 10
    v_add_u32 v71, s28, v68
    s_add_u32 s28, s28, 4096
    s_cmp_eq_u32 s28, 12288
    s_cselect_b32 s28, 0, s28
    v_add_u32 v79, s28, v68
    s_add_u32 s28, s28, 4096
    s_cmp_eq_u32 s28, 12288
    s_cselect_b32 s28, 0, s28
    v_add_u32 v78, s28, v68
    s_mul_i32 s28, s22, 3
    s_add_u32 s28, s28, 12
    s_sub_u32 s26, s28, s26
    v_add_u32 v216, 4096, v68
    v_lshlrev_b32 v73, 3, v1
    v_xor_b32 v4, s74, v3
    v_lshrrev_b32 v5, 3, v2
    v_lshl_add_u32 v5, v4, 1, v5
    v_mul_u32_u24 v5, 768, v5
    v_and_b32 v4, 7, v2
    v_lshl_add_u32 v206, v4, 3, v5
    s_mul_i32 s14, s20, 24576
    s_mul_i32 s28, s22, 6144
    s_add_u32 s14, s14, s28
    s_add_u32 s14, s14, 503808
    s_mul_i32 s28, s22, 768
    s_add_u32 s28, s28, 151040
    v_lshlrev_b32 v4, 2, v1
    v_add_u32 v217, s28, v4
    v_lshlrev_b32 v244, 3, v2
    v_lshlrev_b32 v218, 4, v3
    v_add_u32 v219, s28, v218
    s_lshl_b32 s30, s20, 2
    s_add_u32 s30, s30, s22
    s_mul_i32 s30, s30, 49152
    s_add_u32 s30, s30, 1617920
    s_mul_i32 s28, s74, 12288
    s_add_u32 s76, s30, s28
    s_add_u32 s77, s76, 12288
    s_sub_u32 s78, s30, s28
    s_add_u32 s78, s78, 24576
    s_add_u32 s79, s78, 12288
    s_bfe_u32 s28, s21, 0x20002
    s_sub_u32 s81, s28, s22
    s_mul_i32 s81, s81, 49152
    s_add_u32 s81, s81, s76
    s_and_b32 s28, s22, 1
    s_mul_i32 s28, s28, 12288
    s_add_u32 s81, s81, s28
    s_and_b32 s28, s21, 3
    s_mul_i32 s28, s28, 3072
    s_add_u32 s81, s81, s28
    s_lshr_b32 s28, s22, 1
    s_lshl_b32 s28, s28, 10
    s_add_u32 s80, s28, s81
    s_lshl_b32 s19, s2, 7
    s_lshl_b32 s28, s22, 2
    s_add_u32 s19, s19, s28
    s_add_u32 s19, s19, 77824
    s_bfe_u32 s30, s21, 0x30001
    s_mul_i32 s66, s30, 73728
    s_mul_i32 s28, s22, 18432
    s_add_u32 s66, s66, s28
    s_add_u32 s66, s66, 1028096
    s_mul_i32 s15, s30, 3072
    s_add_u32 s15, s15, 6336512
    s_and_b32 s29, s21, 1
    s_lshl_b32 s28, s29, 10
    s_add_u32 s67, s66, s28
    s_lshl_b32 s28, s29, 12
    s_add_u32 s66, s66, s28
    s_lshl_b32 s28, s29, 9
    s_add_u32 s16, s15, s28
    s_lshl_b32 s28, s29, 11
    s_add_u32 s15, s15, s28
    s_lshl_b32 s18, s20, 2
    s_add_u32 s18, s18, s74
    s_lshl_b32 s18, s18, 1
    s_add_u32 s18, s18, s22
    s_mul_i32 s3, s18, 24576
    s_mul_i32 s28, s30, 3072
    s_add_u32 s3, s3, s28
    s_add_u32 s3, s3, 3190784
    s_lshl_b32 s28, s29, 3
    s_add_u32 s17, s3, s28
    s_add_u32 s17, s17, 1024
    s_lshl_b32 s28, s29, 11
    s_add_u32 s3, s3, s28
    s_lshl_b32 s18, s18, 10
    s_lshl_b32 s28, s30, 7
    s_add_u32 s18, s18, s28
    s_lshl_b32 s28, s29, 2
    s_add_u32 s18, s18, s28
    s_add_u32 s18, s18, 6483968
    s_bitcmp0_b32 s21, 3
    s_cbranch_scc1 L_p2s_7
    s_lshl_b32 s3, s20, 2
    s_add_u32 s3, s3, s30
    s_sub_u32 s3, s3, 4
    s_mul_i32 s3, s3, 49152
    s_lshl_b32 s28, s22, 2
    s_add_u32 s28, s28, s74
    s_mul_i32 s28, s28, 3072
    s_add_u32 s3, s3, s28
    s_add_u32 s3, s3, 4763648
    s_lshl_b32 s28, s29, 10
    s_add_u32 s17, s3, s28
    s_lshl_b32 s28, s29, 12
    s_add_u32 s3, s3, s28
L_p2s_7:
    s_mov_b32 s1, 1
L_wvo_on:
    s_waitcnt vmcnt(8)
    s_barrier
    ds_read_b128 v[80:83], v236 offset:0
    buffer_load_dwordx4 v[180:183], v204, s[32:35], s64 offen offset:0 sc1
    ds_read_b128 v[84:87], v236 offset:1024
    ds_read_b128 v[88:91], v236 offset:2048
    buffer_load_dwordx4 v[184:187], v204, s[32:35], s64 offen offset:512 sc1
    ds_read_b128 v[92:95], v236 offset:3072
    ds_read_b128 v[96:99], v236 offset:4096
    buffer_load_dwordx4 v[188:191], v204, s[32:35], s64 offen offset:1024 sc1
    ds_read_b128 v[100:103], v236 offset:5120
    ds_read_b128 v[104:107], v236 offset:6144
    buffer_load_dwordx4 v[220:223], v204, s[32:35], s64 offen offset:1536 sc1
    ds_read_b128 v[108:111], v236 offset:7168
    ds_read_b128 v[112:115], v236 offset:8192
    buffer_load_dwordx4 v[224:227], v204, s[32:35], s64 offen offset:2048 sc1
    ds_read_b128 v[116:119], v236 offset:9216
    s_waitcnt lgkmcnt(9)
    v_mfma_f32_16x16x32_bf16 v[144:147], v[16:19], v[80:83], 0
    ds_read_b128 v[120:123], v236 offset:10240
    s_waitcnt lgkmcnt(9)
    v_mfma_f32_16x16x32_bf16 v[148:151], v[16:19], v[84:87], 0
    buffer_load_dwordx4 v[248:251], v204, s[32:35], s64 offen offset:2560 sc1
    ds_read_b128 v[124:127], v236 offset:11264
    s_waitcnt lgkmcnt(9)
    v_mfma_f32_16x16x32_bf16 v[152:155], v[16:19], v[88:91], 0
    ds_read_b128 v[128:131], v236 offset:12288
    s_waitcnt lgkmcnt(9)
    v_mfma_f32_16x16x32_bf16 v[156:159], v[16:19], v[92:95], 0
    ds_read_b128 v[132:135], v236 offset:13312
    s_waitcnt lgkmcnt(9)
    v_mfma_f32_16x16x32_bf16 v[144:147], v[20:23], v[96:99], v[144:147]
    ds_read_b128 v[136:139], v236 offset:14336
    s_waitcnt lgkmcnt(9)
    v_mfma_f32_16x16x32_bf16 v[148:151], v[20:23], v[100:103], v[148:151]
    ds_read_b128 v[140:143], v236 offset:15360
    s_waitcnt lgkmcnt(9)
    v_mfma_f32_16x16x32_bf16 v[152:155], v[20:23], v[104:107], v[152:155]
    s_waitcnt vmcnt(10)
    s_barrier
    ds_read_b128 v[80:83], v236 offset:16384
    s_waitcnt lgkmcnt(9)
    v_mfma_f32_16x16x32_bf16 v[156:159], v[20:23], v[108:111], v[156:159]
    ds_read_b128 v[84:87], v236 offset:17408
    s_waitcnt lgkmcnt(9)
    v_mfma_f32_16x16x32_bf16 v[144:147], v[24:27], v[112:115], v[144:147]
    ds_read_b128 v[88:91], v236 offset:18432
    s_waitcnt lgkmcnt(9)
    v_mfma_f32_16x16x32_bf16 v[148:151], v[24:27], v[116:119], v[148:151]
    ds_read_b128 v[92:95], v236 offset:19456
    s_waitcnt lgkmcnt(9)
    v_mfma_f32_16x16x32_bf16 v[152:155], v[24:27], v[120:123], v[152:155]
    ds_read_b128 v[96:99], v236 offset:20480
    s_waitcnt lgkmcnt(9)
    v_mfma_f32_16x16x32_bf16 v[156:159], v[24:27], v[124:127], v[156:159]
    ds_read_b128 v[100:103], v236 offset:21504
    s_waitcnt lgkmcnt(9)
    v_mfma_f32_16x16x32_bf16 v[144:147], v[28:31], v[128:131], v[144:147]
    ds_read_b128 v[104:107], v236 offset:22528
    s_waitcnt lgkmcnt(9)
    v_mfma_f32_16x16x32_bf16 v[148:151], v[28:31], v[132:135], v[148:151]
    ds_read_b128 v[108:111], v236 offset:23552
    s_waitcnt lgkmcnt(9)
    v_mfma_f32_16x16x32_bf16 v[152:155], v[28:31], v[136:139], v[152:155]
    ds_read_b128 v[112:115], v236 offset:24576
    s_waitcnt lgkmcnt(9)
    v_mfma_f32_16x16x32_bf16 v[156:159], v[28:31], v[140:143], v[156:159]
    ds_read_b128 v[116:119], v236 offset:25600
    s_waitcnt lgkmcnt(9)
    v_mfma_f32_16x16x32_bf16 v[144:147], v[32:35], v[80:83], v[144:147]
    ds_read_b128 v[120:123], v236 offset:26624
    s_waitcnt lgkmcnt(9)
    v_mfma_f32_16x16x32_bf16 v[148:151], v[32:35], v[84:87], v[148:151]
    ds_read_b128 v[124:127], v236 offset:27648
    s_waitcnt lgkmcnt(9)
    v_mfma_f32_16x16x32_bf16 v[152:155], v[32:35], v[88:91], v[152:155]
    ds_read_b128 v[128:131], v236 offset:28672
    s_waitcnt lgkmcnt(9)
    v_mfma_f32_16x16x32_bf16 v[156:159], v[32:35], v[92:95], v[156:159]
    ds_read_b128 v[132:135], v236 offset:29696
    s_waitcnt lgkmcnt(9)
    v_mfma_f32_16x16x32_bf16 v[144:147], v[36:39], v[96:99], v[144:147]
    ds_read_b128 v[136:139], v236 offset:30720
    s_waitcnt lgkmcnt(9)
    v_mfma_f32_16x16x32_bf16 v[148:151], v[36:39], v[100:103], v[148:151]
    ds_read_b128 v[140:143], v236 offset:31744
    s_waitcnt lgkmcnt(9)
    v_mfma_f32_16x16x32_bf16 v[152:155], v[36:39], v[104:107], v[152:155]
    s_waitcnt vmcnt(6)
    s_barrier
    ds_read_b128 v[80:83], v236 offset:32768
    s_waitcnt lgkmcnt(9)
    v_mfma_f32_16x16x32_bf16 v[156:159], v[36:39], v[108:111], v[156:159]
    ds_read_b128 v[84:87], v236 offset:33792
    s_waitcnt lgkmcnt(9)
    v_mfma_f32_16x16x32_bf16 v[144:147], v[40:43], v[112:115], v[144:147]
    ds_read_b128 v[88:91], v236 offset:34816
    s_waitcnt lgkmcnt(9)
    v_mfma_f32_16x16x32_bf16 v[148:151], v[40:43], v[116:119], v[148:151]
    ds_read_b128 v[92:95], v236 offset:35840
    s_waitcnt lgkmcnt(9)
    v_mfma_f32_16x16x32_bf16 v[152:155], v[40:43], v[120:123], v[152:155]
    ds_read_b128 v[96:99], v236 offset:36864
    s_waitcnt lgkmcnt(9)
    v_mfma_f32_16x16x32_bf16 v[156:159], v[40:43], v[124:127], v[156:159]
    ds_read_b128 v[100:103], v236 offset:37888
    s_waitcnt lgkmcnt(9)
    v_mfma_f32_16x16x32_bf16 v[144:147], v[44:47], v[128:131], v[144:147]
    ds_read_b128 v[104:107], v236 offset:38912
    s_waitcnt lgkmcnt(9)
    v_mfma_f32_16x16x32_bf16 v[148:151], v[44:47], v[132:135], v[148:151]
    ds_read_b128 v[108:111], v236 offset:39936
    s_waitcnt lgkmcnt(9)
    v_mfma_f32_16x16x32_bf16 v[152:155], v[44:47], v[136:139], v[152:155]
    ds_read_b128 v[112:115], v236 offset:40960
    s_waitcnt lgkmcnt(9)
    v_mfma_f32_16x16x32_bf16 v[156:159], v[44:47], v[140:143], v[156:159]
    ds_read_b128 v[116:119], v236 offset:41984
    s_waitcnt lgkmcnt(9)
    v_mfma_f32_16x16x32_bf16 v[144:147], v[48:51], v[80:83], v[144:147]
    ds_read_b128 v[120:123], v236 offset:43008
    s_waitcnt lgkmcnt(9)
    v_mfma_f32_16x16x32_bf16 v[148:151], v[48:51], v[84:87], v[148:151]
    ds_read_b128 v[124:127], v236 offset:44032
    s_waitcnt lgkmcnt(9)
    v_mfma_f32_16x16x32_bf16 v[152:155], v[48:51], v[88:91], v[152:155]
    ds_read_b128 v[128:131], v236 offset:45056
    s_waitcnt lgkmcnt(9)
    v_mfma_f32_16x16x32_bf16 v[156:159], v[48:51], v[92:95], v[156:159]
    ds_read_b128 v[132:135], v236 offset:46080
    s_waitcnt lgkmcnt(9)
    v_mfma_f32_16x16x32_bf16 v[144:147], v[52:55], v[96:99], v[144:147]
    ds_read_b128 v[136:139], v236 offset:47104
    s_waitcnt lgkmcnt(9)
    v_mfma_f32_16x16x32_bf16 v[148:151], v[52:55], v[100:103], v[148:151]
    ds_read_b128 v[140:143], v236 offset:48128
    s_waitcnt lgkmcnt(9)
    v_mfma_f32_16x16x32_bf16 v[152:155], v[52:55], v[104:107], v[152:155]
    s_waitcnt lgkmcnt(8)
    v_mfma_f32_16x16x32_bf16 v[156:159], v[52:55], v[108:111], v[156:159]
    s_waitcnt lgkmcnt(7)
    v_mfma_f32_16x16x32_bf16 v[144:147], v[56:59], v[112:115], v[144:147]
    s_waitcnt lgkmcnt(6)
    v_mfma_f32_16x16x32_bf16 v[148:151], v[56:59], v[116:119], v[148:151]
    s_waitcnt lgkmcnt(5)
    v_mfma_f32_16x16x32_bf16 v[152:155], v[56:59], v[120:123], v[152:155]
    s_waitcnt lgkmcnt(4)
    v_mfma_f32_16x16x32_bf16 v[156:159], v[56:59], v[124:127], v[156:159]
    s_waitcnt lgkmcnt(3)
    v_mfma_f32_16x16x32_bf16 v[144:147], v[60:63], v[128:131], v[144:147]
    s_waitcnt lgkmcnt(2)
    v_mfma_f32_16x16x32_bf16 v[148:151], v[60:63], v[132:135], v[148:151]
    s_waitcnt lgkmcnt(1)
    v_mfma_f32_16x16x32_bf16 v[152:155], v[60:63], v[136:139], v[152:155]
    s_waitcnt lgkmcnt(0)
    v_mfma_f32_16x16x32_bf16 v[156:159], v[60:63], v[140:143], v[156:159]
    s_mov_b64 vcc, 0
    s_cmp_eq_u32 s1, 0
    s_cbranch_scc1 L_s_have
    s_waitcnt vmcnt(0)
    v_xor_b32 v180, s52, v180
    v_xor_b32 v181, s53, v181
    v_xor_b32 v182, s54, v182
    v_xor_b32 v183, s55, v183
    v_or_b32 v6, v180, v181
    v_or3_b32 v6, v6, v182, v183
    v_xor_b32 v184, s52, v184
    v_xor_b32 v185, s53, v185
    v_xor_b32 v186, s54, v186
    v_xor_b32 v187, s55, v187
    v_or3_b32 v6, v6, v184, v185
    v_or3_b32 v6, v6, v186, v187
    v_xor_b32 v188, s52, v188
    v_xor_b32 v189, s53, v189
    v_xor_b32 v190, s54, v190
    v_xor_b32 v191, s55, v191
    v_or3_b32 v6, v6, v188, v189
    v_or3_b32 v6, v6, v190, v191
    v_xor_b32 v220, s52, v220
    v_xor_b32 v221, s53, v221
    v_xor_b32 v222, s54, v222
    v_xor_b32 v223, s55, v223
    v_or3_b32 v6, v6, v220, v221
    v_or3_b32 v6, v6, v222, v223
    v_xor_b32 v224, s52, v224
    v_xor_b32 v225, s53, v225
    v_xor_b32 v226, s54, v226
    v_xor_b32 v227, s55, v227
    v_or3_b32 v6, v6, v224, v225
    v_or3_b32 v6, v6, v226, v227
    v_xor_b32 v248, s52, v248
    v_xor_b32 v249, s53, v249
    v_xor_b32 v250, s54, v250
    v_xor_b32 v251, s55, v251
    v_or3_b32 v6, v6, v248, v249
    v_or3_b32 v6, v6, v250, v251
    v_and_b32 v6, 0xff, v6
    v_pk_add_f32 v[184:185], v[184:185], v[180:181]
    v_pk_add_f32 v[186:187], v[186:187], v[182:183]
    v_pk_add_f32 v[220:221], v[220:221], v[188:189]
    v_pk_add_f32 v[222:223], v[222:223], v[190:191]
    v_pk_add_f32 v[248:249], v[248:249], v[224:225]
    v_pk_add_f32 v[250:251], v[250:251], v[226:227]
    v_pk_add_f32 v[220:221], v[220:221], v[184:185]
    v_pk_add_f32 v[222:223], v[222:223], v[186:187]
    v_pk_add_f32 v[248:249], v[248:249], v[220:221]
    v_pk_add_f32 v[250:251], v[250:251], v[222:223]
    v_mul_f32 v248, v248, v212
    v_mul_f32 v249, v249, v213
    v_mul_f32 v250, v250, v214
    v_mul_f32 v251, v251, v215
    v_max3_f32 v4, v248, v249, v250
    v_max_f32 v4, v4, v251
    v_mov_b32 v5, v4
    s_nop 1
    v_permlane16_swap_b32 v4, v5
    s_nop 0
    v_max_f32 v4, v4, v5
    v_sub_f32 v248, v248, v4
    v_sub_f32 v249, v249, v4
    v_sub_f32 v250, v250, v4
    v_sub_f32 v251, v251, v4
    v_exp_f32 v248, v248
    v_exp_f32 v249, v249
    v_exp_f32 v250, v250
    v_exp_f32 v251, v251
    s_nop 0
    v_add_f32 v4, v248, v249
    v_add_f32 v5, v250, v251
    v_add_f32 v4, v4, v5
    v_mov_b32 v5, v4
    v_mul_f32 v248, v248, v208
    v_mul_f32 v249, v249, v209
    v_permlane16_swap_b32 v4, v5
    v_mul_f32 v250, v250, v210
    v_add_f32 v4, v4, v5
    v_rcp_f32 v4, v4
    v_mul_f32 v251, v251, v211
    v_cndmask_b32 v4, 0, v4, s[48:49]
    v_mul_f32 v248, v248, v4
    v_mul_f32 v249, v249, v4
    v_mul_f32 v250, v250, v4
    v_mul_f32 v251, v251, v4
    v_cvt_pk_bf16_f32 v200, v248, v249
    v_cvt_pk_bf16_f32 v201, v250, v251
    v_cmp_ne_u32 vcc, 0, v6
L_s_have:
    s_nop 1
    v_cvt_pk_bf16_f32 v88, v144, v145
    v_cvt_pk_bf16_f32 v89, v146, v147
    v_cvt_pk_bf16_f32 v90, v148, v149
    v_cvt_pk_bf16_f32 v91, v150, v151
    v_cvt_pk_bf16_f32 v92, v152, v153
    v_cvt_pk_bf16_f32 v93, v154, v155
    v_cvt_pk_bf16_f32 v94, v156, v157
    v_cvt_pk_bf16_f32 v95, v158, v159
    s_cbranch_vccz L_sok
    s_mov_b32 s31, 40000
L_spoll:
    buffer_load_dwordx4 v[180:183], v204, s[32:35], s64 offen offset:0 sc1
    buffer_load_dwordx4 v[184:187], v204, s[32:35], s64 offen offset:512 sc1
    buffer_load_dwordx4 v[188:191], v204, s[32:35], s64 offen offset:1024 sc1
    buffer_load_dwordx4 v[220:223], v204, s[32:35], s64 offen offset:1536 sc1
    buffer_load_dwordx4 v[224:227], v204, s[32:35], s64 offen offset:2048 sc1
    buffer_load_dwordx4 v[248:251], v204, s[32:35], s64 offen offset:2560 sc1
    s_waitcnt vmcnt(0)
    v_xor_b32 v180, s52, v180
    v_xor_b32 v181, s53, v181
    v_xor_b32 v182, s54, v182
    v_xor_b32 v183, s55, v183
    v_or_b32 v6, v180, v181
    v_or3_b32 v6, v6, v182, v183
    v_xor_b32 v184, s52, v184
    v_xor_b32 v185, s53, v185
    v_xor_b32 v186, s54, v186
    v_xor_b32 v187, s55, v187
    v_or3_b32 v6, v6, v184, v185
    v_or3_b32 v6, v6, v186, v187
    v_xor_b32 v188, s52, v188
    v_xor_b32 v189, s53, v189
    v_xor_b32 v190, s54, v190
    v_xor_b32 v191, s55, v191
    v_or3_b32 v6, v6, v188, v189
    v_or3_b32 v6, v6, v190, v191
    v_xor_b32 v220, s52, v220
    v_xor_b32 v221, s53, v221
    v_xor_b32 v222, s54, v222
    v_xor_b32 v223, s55, v223
    v_or3_b32 v6, v6, v220, v221
    v_or3_b32 v6, v6, v222, v223
    v_xor_b32 v224, s52, v224
    v_xor_b32 v225, s53, v225
    v_xor_b32 v226, s54, v226
    v_xor_b32 v227, s55, v227
    v_or3_b32 v6, v6, v224, v225
    v_or3_b32 v6, v6, v226, v227
    v_xor_b32 v248, s52, v248
    v_xor_b32 v249, s53, v249
    v_xor_b32 v250, s54, v250
    v_xor_b32 v251, s55, v251
    v_or3_b32 v6, v6, v248, v249
    v_or3_b32 v6, v6, v250, v251
    v_and_b32 v6, 0xff, v6
    v_cmp_ne_u32 vcc, 0, v6
    s_cbranch_vccz L_sre
    s_sub_u32 s31, s31, 1
    s_cbranch_scc0 L_spoll
L_sre:
    v_pk_add_f32 v[184:185], v[184:185], v[180:181]
    v_pk_add_f32 v[186:187], v[186:187], v[182:183]
    v_pk_add_f32 v[220:221], v[220:221], v[188:189]
    v_pk_add_f32 v[222:223], v[222:223], v[190:191]
    v_pk_add_f32 v[248:249], v[248:249], v[224:225]
    v_pk_add_f32 v[250:251], v[250:251], v[226:227]
    v_pk_add_f32 v[220:221], v[220:221], v[184:185]
    v_pk_add_f32 v[222:223], v[222:223], v[186:187]
    v_pk_add_f32 v[248:249], v[248:249], v[220:221]
    v_pk_add_f32 v[250:251], v[250:251], v[222:223]
    v_mul_f32 v248, v248, v212
    v_mul_f32 v249, v249, v213
    v_mul_f32 v250, v250, v214
    v_mul_f32 v251, v251, v215
    v_max3_f32 v4, v248, v249, v250
    v_max_f32 v4, v4, v251
    v_mov_b32 v5, v4
    s_nop 1
    v_permlane16_swap_b32 v4, v5
    s_nop 0
    v_max_f32 v4, v4, v5
    v_sub_f32 v248, v248, v4
    v_sub_f32 v249, v249, v4
    v_sub_f32 v250, v250, v4
    v_sub_f32 v251, v251, v4
    v_exp_f32 v248, v248
    v_exp_f32 v249, v249
    v_exp_f32 v250, v250
    v_exp_f32 v251, v251
    s_nop 0
    v_add_f32 v4, v248, v249
    v_add_f32 v5, v250, v251
    v_add_f32 v4, v4, v5
    v_mov_b32 v5, v4
    v_mul_f32 v248, v248, v208
    v_mul_f32 v249, v249, v209
    v_permlane16_swap_b32 v4, v5
    v_mul_f32 v250, v250, v210
    v_add_f32 v4, v4, v5
    v_rcp_f32 v4, v4
    v_mul_f32 v251, v251, v211
    v_cndmask_b32 v4, 0, v4, s[48:49]
    v_mul_f32 v248, v248, v4
    v_mul_f32 v249, v249, v4
    v_mul_f32 v250, v250, v4
    v_mul_f32 v251, v251, v4
    v_cvt_pk_bf16_f32 v200, v248, v249
    v_cvt_pk_bf16_f32 v201, v250, v251
    s_nop 1
L_sok:
    s_waitcnt vmcnt(0)
    buffer_load_dword v11, v231, s[32:35], 0 offen sc1
    v_mfma_f32_16x16x16_bf16 v[164:167], v[88:89], v[200:201], v[164:167]
    v_mfma_f32_16x16x16_bf16 v[168:171], v[90:91], v[200:201], v[168:171]
    v_mfma_f32_16x16x16_bf16 v[172:175], v[92:93], v[200:201], v[172:175]
    v_mfma_f32_16x16x16_bf16 v[176:179], v[94:95], v[200:201], v[176:179]
    s_nop 4
    v_cvt_pk_bf16_f32 v128, v164, v165
    v_cvt_pk_bf16_f32 v129, v166, v167
    v_cvt_pk_bf16_f32 v130, v168, v169
    v_cvt_pk_bf16_f32 v131, v170, v171
    ds_write_b128 v237, v[128:131] offset:0
    v_cvt_pk_bf16_f32 v132, v172, v173
    v_cvt_pk_bf16_f32 v133, v174, v175
    v_cvt_pk_bf16_f32 v134, v176, v177
    v_cvt_pk_bf16_f32 v135, v178, v179
    ds_write_b128 v237, v[132:135] offset:512
    v_mfma_f32_16x16x32_bf16 v[148:151], v[128:131], v[128:131], 0
    v_mfma_f32_16x16x32_bf16 v[144:147], v[12:15], v[128:131], 0
    v_mfma_f32_16x16x32_bf16 v[148:151], v[132:135], v[132:135], v[148:151]
    v_mfma_f32_16x16x32_bf16 v[144:147], v[12:15], v[132:135], v[144:147]
    s_nop 6
    v_cndmask_b32 v148, v148, v149, s[4:5]
    v_cndmask_b32 v148, v148, v150, s[6:7]
    v_cndmask_b32 v145, v148, v151, s[8:9]
    s_mov_b64 exec, s[100:101]
    ds_write_b64 v238, v[144:145]
    s_mov_b64 exec, -1
    s_waitcnt lgkmcnt(0)
    s_barrier
    ds_read_b128 v[128:131], v239
    ds_read_b128 v[132:135], v240 offset:1024
    ds_read_b64 v[4:5], v243
    s_waitcnt lgkmcnt(2)
    buffer_store_dwordx4 v[128:131], v241, s[32:35], s73 offen sc1
    s_waitcnt lgkmcnt(1)
    buffer_store_dwordx4 v[132:135], v241, s[32:35], s69 offen sc1
    s_cmp_lg_u32 s22, 0
    s_cbranch_scc1 L_nostx
    s_waitcnt lgkmcnt(0)
    v_bfi_b32 v4, v69, v4, s52
    v_bfi_b32 v5, v69, v5, s53
    buffer_store_dwordx2 v[4:5], v242, s[32:35], s75 offen sc1
    s_waitcnt vmcnt(3)
    s_branch L_stx2
L_nostx:
    s_waitcnt vmcnt(2)
L_stx2:
    v_cmp_ne_u32 vcc, s23, v11
    s_cbranch_vccz L_p2
    s_mov_b32 s31, 40000
L_pws_9:
    buffer_load_dword v11, v231, s[32:35], 0 offen sc1
    s_waitcnt vmcnt(0)
    v_cmp_ne_u32 vcc, s23, v11
    s_cbranch_vccz L_pws_ok_10
    s_sub_u32 s31, s31, 1
    s_cbranch_scc0 L_pws_9
L_pws_ok_10:
L_p2:
    buffer_load_dwordx2 v[80:81], v73, s[32:35], s15 offen offset:0 sc1
    buffer_load_dwordx2 v[84:85], v73, s[32:35], s15 offen offset:512 sc1
    buffer_load_dwordx2 v[88:89], v73, s[32:35], s16 offen offset:1024 sc1
    s_add_u32 s28, s26, 0
    s_cmp_ge_u32 s28, 12
    s_cselect_b32 s29, 12, 0
    s_sub_u32 s28, s28, s29
    s_mul_i32 s28, s28, 3072
    s_add_u32 m0, s28, 0
    s_add_u32 s28, s66, 0
    s_add_u32 s29, s67, 0
    buffer_load_dwordx4 v68, s[32:35], s28 offen sc1 lds
    buffer_load_dwordx4 v68, s[32:35], s28 offen offset:1024 sc1 lds
    buffer_load_dwordx4 v68, s[32:35], s29 offen offset:2048 sc1 lds
    s_add_u32 s28, s26, 1
    s_cmp_ge_u32 s28, 12
    s_cselect_b32 s29, 12, 0
    s_sub_u32 s28, s28, s29
    s_mul_i32 s28, s28, 3072
    s_add_u32 m0, s28, 0
    s_add_u32 s28, s66, 6144
    s_add_u32 s29, s67, 6144
    buffer_load_dwordx4 v68, s[32:35], s28 offen sc1 lds
    buffer_load_dwordx4 v68, s[32:35], s28 offen offset:1024 sc1 lds
    buffer_load_dwordx4 v68, s[32:35], s29 offen offset:2048 sc1 lds
    s_add_u32 s28, s26, 2
    s_cmp_ge_u32 s28, 12
    s_cselect_b32 s29, 12, 0
    s_sub_u32 s28, s28, s29
    s_mul_i32 s28, s28, 3072
    s_add_u32 m0, s28, 0
    s_add_u32 s28, s66, 12288
    s_add_u32 s29, s67, 12288
    buffer_load_dwordx4 v68, s[32:35], s28 offen sc1 lds
    buffer_load_dwordx4 v68, s[32:35], s28 offen offset:1024 sc1 lds
    buffer_load_dwordx4 v68, s[32:35], s29 offen offset:2048 sc1 lds
L_p2c:
    s_and_b32 s65, s21, 3
    s_bfe_u32 s64, s21, 0x20002
    s_lshl_b32 s4, s20, 7
    s_add_u32 s4, s4, 77824
    v_and_b32 v6, 7, v1
    v_lshlrev_b32 v6, 10, v6
    s_lshl_b32 s28, s74, 13
    s_lshl_b32 s29, s64, 2
    s_add_u32 s28, s28, s29
    v_add_u32 v188, s28, v6
    v_and_b32 v6, 1, v1
    v_lshlrev_b32 v6, 10, v6
    v_and_b32 v7, 2, v1
    v_lshl_add_u32 v6, v7, 13, v6
    s_lshl_b32 s28, s65, 11
    s_lshl_b32 s29, s22, 2
    s_add_u32 s28, s28, s29
    s_add_u32 s28, s28, 8192
    v_add_u32 v191, s28, v6
    s_lshl_b32 s11, s20, 2
    s_add_u32 s13, s11, s65
    s_add_u32 s11, s11, s74
    s_lshl_b32 s11, s11, 1
    s_add_u32 s11, s11, s64
    s_mul_i32 s0, s11, 24576
    s_mul_i32 s29, s22, 3072
    s_add_u32 s0, s0, s29
    s_add_u32 s0, s0, 3190784
    s_lshl_b32 s1, s11, 10
    s_add_u32 s1, s1, 6483968
    s_mul_i32 s75, s13, 49152
    s_mul_i32 s29, s22, 12288
    s_add_u32 s75, s75, s29
    s_add_u32 s75, s75, 4763648
    s_mul_i32 s29, s74, 3072
    s_add_u32 s72, s75, s29
    s_sub_u32 s75, s75, s29
    s_add_u32 s75, s75, 6144
    s_add_u32 s5, s0, 12288
    v_add_u32 v74, 98304, v68
    s_add_u32 s28, s26, 0
    s_cmp_ge_u32 s28, 12
    s_cselect_b32 s29, 12, 0
    s_sub_u32 s28, s28, s29
    s_mul_i32 s28, s28, 1024
    s_add_u32 m0, s28, 98304
    s_mov_b32 s8, m0
    s_add_u32 s28, s26, 1
    s_cmp_ge_u32 s28, 12
    s_cselect_b32 s29, 12, 0
    s_sub_u32 s28, s28, s29
    s_mul_i32 s28, s28, 1024
    s_add_u32 m0, s28, 97280
    s_mov_b32 s9, m0
    s_add_u32 s28, s26, 2
    s_cmp_ge_u32 s28, 12
    s_cselect_b32 s29, 12, 0
    s_sub_u32 s28, s28, s29
    s_mul_i32 s28, s28, 1024
    s_add_u32 m0, s28, 96256
    s_mov_b32 s10, m0
    v_bfe_u32 v6, v2, 1, 2
    v_xor_b32 v6, v6, v3
    v_lshl_add_u32 v6, v2, 2, v6
    v_lshlrev_b32 v6, 4, v6
    s_lshl_b32 s28, s22, 11
    v_add_u32 v75, s28, v6
    s_lshl_b32 s28, s22, 8
    s_add_u32 s28, s28, 150016
    v_lshlrev_b32 v7, 3, v2
    v_add_u32 v76, s28, v7
    s_and_b32 s13, s22, 1
    s_lshl_b32 s28, s13, 7
    s_add_u32 s28, s28, 150016
    v_lshrrev_b32 v8, 2, v1
    v_lshlrev_b32 v7, 3, v8
    v_add_u32 v77, s28, v7
    v_bfe_u32 v7, v1, 3, 2
    v_xor_b32 v7, v7, v1
    v_lshlrev_b32 v7, 4, v7
    s_lshl_b32 s28, s22, 13
    v_add_u32 v213, s28, v7
    v_and_b32 v7, 3, v1
    v_lshlrev_b32 v6, 4, v8
    v_lshl_add_u32 v190, v7, 8, v6
    s_lshl_b32 s7, s64, 2
    s_add_u32 s7, s7, s74
    s_add_u32 s7, s7, s13
    s_lshl_b32 s7, s7, 4
    s_lshl_b32 s29, s20, 8
    s_add_u32 s7, s7, s29
    s_mul_i32 s7, s7, 768
    s_mul_i32 s29, s65, 192
    s_add_u32 s7, s7, s29
    s_lshr_b32 s29, s22, 1
    s_lshl_b32 s29, s29, 6
    s_add_u32 s6, s29, s7
    v_mul_u32_u24 v8, 768, v8
    v_lshl_add_u32 v70, v7, 4, v8
L_p2d:
    s_bitcmp1_b32 s21, 3
    s_cbranch_scc1 L_nomark
    v_mov_b32 v220, -1
    v_mov_b32 v221, -1
    v_mov_b32 v222, -1
    v_mov_b32 v223, -1
    s_cmp_lg_u32 s61, 0
    s_cbranch_scc1 L_slow_11
    s_add_u32 s28, s3, 12288
    s_add_u32 s29, s17, 12288
    buffer_store_dwordx4 v[220:223], v68, s[32:35], s3 offen
    buffer_store_dwordx4 v[220:223], v68, s[32:35], s28 offen
    buffer_store_dwordx2 v[220:221], v68, s[32:35], s17 offen
    buffer_store_dwordx2 v[220:221], v68, s[32:35], s29 offen
    s_branch L_join_12
L_slow_11:
    s_add_u32 s28, s3, 12288
    s_add_u32 s29, s17, 12288
    buffer_store_dwordx4 v[220:223], v68, s[32:35], s3 offen sc1
    buffer_store_dwordx4 v[220:223], v68, s[32:35], s28 offen sc1
    buffer_store_dwordx2 v[220:221], v68, s[32:35], s17 offen sc1
    buffer_store_dwordx2 v[220:221], v68, s[32:35], s29 offen sc1
L_join_12:
    s_waitcnt vmcnt(13)
    s_branch L_marked
L_nomark:
    s_waitcnt vmcnt(9)
L_marked:
    v_add_f32 v80, v80, v81
    v_add_f32 v84, v84, v85
    v_add_f32 v88, v88, v89
    v_mov_b32 v81, v80
    v_mov_b32 v85, v84
    v_mov_b32 v89, v88
    v_permlane16_swap_b32 v80, v81
    v_permlane16_swap_b32 v84, v85
    v_permlane16_swap_b32 v88, v89
    v_add_f32 v80, v80, v81
    v_add_f32 v84, v84, v85
    v_add_f32 v88, v88, v89
    v_mov_b32 v81, v80
    v_mov_b32 v85, v84
    v_mov_b32 v89, v88
    v_permlane32_swap_b32 v80, v81
    v_permlane32_swap_b32 v84, v85
    v_permlane32_swap_b32 v88, v89
    v_add_f32 v80, v80, v81
    v_add_f32 v84, v84, v85
    v_add_f32 v88, v88, v89
    v_cvt_pk_bf16_f32 v176, v80, v80
    v_lshlrev_b32 v177, 16, v176
    v_sub_f32 v177, v80, v177
    v_cvt_pk_bf16_f32 v177, v177, v177
    v_cvt_pk_bf16_f32 v178, v84, v84
    v_lshlrev_b32 v179, 16, v178
    v_sub_f32 v179, v84, v179
    v_cvt_pk_bf16_f32 v179, v179, v179
    v_cvt_pk_bf16_f32 v180, v88, v88
    v_lshlrev_b32 v181, 16, v180
    v_sub_f32 v181, v88, v181
    v_cvt_pk_bf16_f32 v181, v181, v181
    s_mov_b32 s31, 40000
    s_mov_b32 s70, 64
L_px:
    buffer_load_dwordx2 v[192:193], v206, s[32:35], s14 offen offset:0 sc1
    buffer_load_dwordx2 v[194:195], v206, s[32:35], s14 offen offset:128 sc1
    buffer_load_dwordx2 v[196:197], v206, s[32:35], s14 offen offset:256 sc1
    buffer_load_dwordx2 v[198:199], v206, s[32:35], s14 offen offset:384 sc1
    buffer_load_dwordx2 v[200:201], v206, s[32:35], s14 offen offset:512 sc1
    buffer_load_dwordx2 v[202:203], v206, s[32:35], s14 offen offset:640 sc1
L_px1:
    s_waitcnt vmcnt(0)
    v_xor_b32 v192, s52, v192
    v_xor_b32 v193, s53, v193
    v_xor_b32 v194, s52, v194
    v_xor_b32 v195, s53, v195
    v_xor_b32 v196, s52, v196
    v_xor_b32 v197, s53, v197
    v_xor_b32 v198, s52, v198
    v_xor_b32 v199, s53, v199
    v_xor_b32 v200, s52, v200
    v_xor_b32 v201, s53, v201
    v_xor_b32 v202, s52, v202
    v_xor_b32 v203, s53, v203
    v_or3_b32 v4, v192, v193, v194
    v_or3_b32 v4, v4, v195, v196
    v_or3_b32 v4, v4, v197, v198
    v_or3_b32 v4, v4, v199, v200
    v_or3_b32 v4, v4, v201, v202
    v_or_b32 v4, v4, v203
    v_and_b32 v4, 0xff, v4
    v_cmp_ne_u32 vcc, 0, v4
    s_cbranch_vccz L_pxok
    s_sub_u32 s31, s31, 1
    s_cbranch_scc0 L_px
L_pxok:
    buffer_load_dwordx4 v[16:19], v71, s[32:35], s76 offen offset:0 sc1
    buffer_load_dwordx4 a[0:3], v71, s[32:35], s77 offen offset:0 sc1
    buffer_load_dwordx4 v[20:23], v71, s[32:35], s76 offen offset:1024 sc1
    buffer_load_dwordx4 a[4:7], v71, s[32:35], s77 offen offset:1024 sc1
    buffer_load_dwordx4 v[24:27], v71, s[32:35], s76 offen offset:2048 sc1
    buffer_load_dwordx4 a[8:11], v71, s[32:35], s77 offen offset:2048 sc1
    buffer_load_dwordx4 v[28:31], v71, s[32:35], s76 offen offset:3072 sc1
    buffer_load_dwordx4 a[12:15], v71, s[32:35], s77 offen offset:3072 sc1
    buffer_load_dwordx4 v[32:35], v79, s[32:35], s76 offen offset:0 sc1
    buffer_load_dwordx4 a[16:19], v79, s[32:35], s77 offen offset:0 sc1
    buffer_load_dwordx4 v[36:39], v79, s[32:35], s76 offen offset:1024 sc1
    buffer_load_dwordx4 a[20:23], v79, s[32:35], s77 offen offset:1024 sc1
    s_barrier
    s_bitcmp0_b32 s21, 3
    s_cbranch_scc0 L_p2_v
    v_pk_add_f32 v[192:193], v[192:193], v[194:195]
    v_pk_add_f32 v[192:193], v[192:193], v[196:197]
    v_pk_add_f32 v[192:193], v[192:193], v[198:199]
    v_pk_add_f32 v[192:193], v[192:193], v[200:201]
    v_pk_add_f32 v[192:193], v[192:193], v[202:203]
    v_mul_f32 v204, 0x3b2aaaab, v192
    v_mul_f32 v205, 0x3b2aaaab, v193
    v_fma_f32 v205, -v204, v204, v205
    v_max_f32 v205, 0, v205
    v_add_f32 v205, 0x3727c5ac, v205
    v_rsq_f32 v205, v205
    s_nop 0
    v_mul_f32 v212, v204, v205
    ds_write_b32 v217, v205
    ds_write_b32 v217, v212 offset:256
    v_mov_b32 v67, v204
    v_mov_b32 v194, v204
    s_nop 1
    v_permlane16_swap_b32 v67, v194
    s_nop 0
    v_mov_b32 v196, v67
    v_mov_b32 v197, v194
    s_nop 1
    v_permlane32_swap_b32 v67, v196
    v_permlane32_swap_b32 v194, v197
    s_nop 0
    v_mov_b32 v66, v205
    v_mov_b32 v195, v205
    s_nop 1
    v_permlane16_swap_b32 v66, v195
    s_nop 0
    v_mov_b32 v196, v66
    v_mov_b32 v197, v195
    s_nop 1
    v_permlane32_swap_b32 v66, v196
    v_permlane32_swap_b32 v195, v197
    s_nop 0
    v_cvt_pk_bf16_f32 v5, -v67, -v67
    v_lshlrev_b32 v5, 16, v5
    v_sub_f32 v5, -v67, v5
    v_cvt_pk_bf16_f32 v5, -v67, v5
    v_cndmask_b32 v64, 0, v5, s[50:51]
    v_cndmask_b32 v65, 0, v5, s[50:51]
    v_cvt_pk_bf16_f32 v5, -v194, -v194
    v_lshlrev_b32 v5, 16, v5
    v_sub_f32 v5, -v194, v5
    v_cvt_pk_bf16_f32 v5, -v194, v5
    v_cndmask_b32 v240, 0, v5, s[50:51]
    v_cndmask_b32 v241, 0, v5, s[50:51]
    v_mul_f32 v4, 0x3d96c740, v66
    v_mul_f32 v5, 0x3d96c740, v66
    v_mul_f32 v242, 0x3d96c740, v195
    v_mul_f32 v243, 0x3d96c740, v195
    s_waitcnt lgkmcnt(0)
L_p2_go0:
    ds_read_b128 v[80:83], v68 offset:0
    ds_read_b128 v[84:87], v68 offset:1024
    ds_read_b128 v[88:91], v68 offset:2048
    ds_read_b128 v[92:95], v68 offset:3072
    ds_read_b128 v[96:99], v68 offset:4096
    ds_read_b128 v[100:103], v68 offset:5120
    ds_read_b128 v[104:107], v68 offset:6144
    ds_read_b128 v[108:111], v68 offset:7168
    s_waitcnt lgkmcnt(7)
    s_waitcnt vmcnt(11)
    v_mfma_f32_16x16x32_bf16 v[144:147], v[80:83], v[16:19], 0
    buffer_load_dwordx4 v[40:43], v79, s[32:35], s76 offen offset:2048 sc1
    s_waitcnt vmcnt(11)
    v_mfma_f32_16x16x32_bf16 v[156:159], v[80:83], a[0:3], 0
    ds_read_b128 v[112:115], v68 offset:8192
    s_waitcnt lgkmcnt(7)
    v_mfma_f32_16x16x32_bf16 v[148:151], v[84:87], v[16:19], 0
    buffer_load_dwordx4 a[24:27], v79, s[32:35], s77 offen offset:2048 sc1
    v_mfma_f32_16x16x32_bf16 v[160:163], v[84:87], a[0:3], 0
    ds_read_b128 v[116:119], v68 offset:9216
    s_waitcnt lgkmcnt(7)
    v_mfma_f32_16x16x32_bf16 v[152:155], v[88:91], v[16:19], 0
    buffer_load_dwordx4 v[44:47], v79, s[32:35], s76 offen offset:3072 sc1
    v_mfma_f32_16x16x32_bf16 v[164:167], v[88:91], a[0:3], 0
    ds_read_b128 v[120:123], v68 offset:10240
    s_waitcnt lgkmcnt(7)
    s_waitcnt vmcnt(12)
    v_mfma_f32_16x16x32_bf16 v[144:147], v[92:95], v[20:23], v[144:147]
    buffer_load_dwordx4 a[28:31], v79, s[32:35], s77 offen offset:3072 sc1
    s_waitcnt vmcnt(12)
    v_mfma_f32_16x16x32_bf16 v[156:159], v[92:95], a[4:7], v[156:159]
    ds_read_b128 v[124:127], v68 offset:11264
    s_waitcnt lgkmcnt(7)
    v_mfma_f32_16x16x32_bf16 v[148:151], v[96:99], v[20:23], v[148:151]
    buffer_load_dwordx4 v[48:51], v78, s[32:35], s76 offen offset:0 sc1
    v_mfma_f32_16x16x32_bf16 v[160:163], v[96:99], a[4:7], v[160:163]
    ds_read_b128 v[128:131], v68 offset:12288
    s_waitcnt lgkmcnt(7)
    v_mfma_f32_16x16x32_bf16 v[152:155], v[100:103], v[20:23], v[152:155]
    buffer_load_dwordx4 a[32:35], v78, s[32:35], s77 offen offset:0 sc1
    v_mfma_f32_16x16x32_bf16 v[164:167], v[100:103], a[4:7], v[164:167]
    ds_read_b128 v[132:135], v68 offset:13312
    s_waitcnt lgkmcnt(7)
    s_waitcnt vmcnt(13)
    v_mfma_f32_16x16x32_bf16 v[144:147], v[104:107], v[24:27], v[144:147]
    buffer_load_dwordx4 v[52:55], v78, s[32:35], s76 offen offset:1024 sc1
    s_waitcnt vmcnt(13)
    v_mfma_f32_16x16x32_bf16 v[156:159], v[104:107], a[8:11], v[156:159]
    ds_read_b128 v[136:139], v68 offset:14336
    s_waitcnt lgkmcnt(7)
    v_mfma_f32_16x16x32_bf16 v[148:151], v[108:111], v[24:27], v[148:151]
    buffer_load_dwordx4 a[36:39], v78, s[32:35], s77 offen offset:1024 sc1
    v_mfma_f32_16x16x32_bf16 v[160:163], v[108:111], a[8:11], v[160:163]
    ds_read_b128 v[140:143], v68 offset:15360
    s_waitcnt lgkmcnt(7)
    v_mfma_f32_16x16x32_bf16 v[152:155], v[112:115], v[24:27], v[152:155]
    buffer_load_dwordx4 v[56:59], v78, s[32:35], s76 offen offset:2048 sc1
    v_mfma_f32_16x16x32_bf16 v[164:167], v[112:115], a[8:11], v[164:167]
    ds_read_b128 v[80:83], v68 offset:16384
    s_waitcnt lgkmcnt(7)
    s_waitcnt vmcnt(14)
    v_mfma_f32_16x16x32_bf16 v[144:147], v[116:119], v[28:31], v[144:147]
    buffer_load_dwordx4 a[40:43], v78, s[32:35], s77 offen offset:2048 sc1
    s_waitcnt vmcnt(14)
    v_mfma_f32_16x16x32_bf16 v[156:159], v[116:119], a[12:15], v[156:159]
    ds_read_b128 v[84:87], v68 offset:17408
    s_waitcnt lgkmcnt(7)
    v_mfma_f32_16x16x32_bf16 v[148:151], v[120:123], v[28:31], v[148:151]
    buffer_load_dwordx4 v[60:63], v78, s[32:35], s76 offen offset:3072 sc1
    v_mfma_f32_16x16x32_bf16 v[160:163], v[120:123], a[12:15], v[160:163]
    ds_read_b128 v[88:91], v68 offset:18432
    s_waitcnt lgkmcnt(7)
    v_mfma_f32_16x16x32_bf16 v[152:155], v[124:127], v[28:31], v[152:155]
    buffer_load_dwordx4 a[44:47], v78, s[32:35], s77 offen offset:3072 sc1
    v_mfma_f32_16x16x32_bf16 v[164:167], v[124:127], a[12:15], v[164:167]
    ds_read_b128 v[92:95], v68 offset:19456
    s_waitcnt lgkmcnt(7)
    s_waitcnt vmcnt(15)
    v_mfma_f32_16x16x32_bf16 v[144:147], v[128:131], v[32:35], v[144:147]
    s_waitcnt vmcnt(14)
    v_mfma_f32_16x16x32_bf16 v[156:159], v[128:131], a[16:19], v[156:159]
    ds_read_b128 v[96:99], v68 offset:20480
    s_waitcnt lgkmcnt(7)
    v_mfma_f32_16x16x32_bf16 v[148:151], v[132:135], v[32:35], v[148:151]
    buffer_load_dwordx4 a[48:51], v71, s[32:35], s78 offen offset:0 sc1
    v_mfma_f32_16x16x32_bf16 v[160:163], v[132:135], a[16:19], v[160:163]
    ds_read_b128 v[100:103], v68 offset:21504
    s_waitcnt lgkmcnt(7)
    v_mfma_f32_16x16x32_bf16 v[152:155], v[136:139], v[32:35], v[152:155]
    v_mfma_f32_16x16x32_bf16 v[164:167], v[136:139], a[16:19], v[164:167]
    ds_read_b128 v[104:107], v68 offset:22528
    s_waitcnt lgkmcnt(7)
    s_waitcnt vmcnt(14)
    v_mfma_f32_16x16x32_bf16 v[144:147], v[140:143], v[36:39], v[144:147]
    buffer_load_dwordx4 a[52:55], v71, s[32:35], s78 offen offset:1024 sc1
    s_waitcnt vmcnt(14)
    v_mfma_f32_16x16x32_bf16 v[156:159], v[140:143], a[20:23], v[156:159]
    ds_read_b128 v[108:111], v68 offset:23552
    s_waitcnt lgkmcnt(7)
    v_mfma_f32_16x16x32_bf16 v[148:151], v[80:83], v[36:39], v[148:151]
    v_mfma_f32_16x16x32_bf16 v[160:163], v[80:83], a[20:23], v[160:163]
    ds_read_b128 v[112:115], v68 offset:24576
    s_waitcnt lgkmcnt(7)
    v_mfma_f32_16x16x32_bf16 v[152:155], v[84:87], v[36:39], v[152:155]
    buffer_load_dwordx4 a[56:59], v71, s[32:35], s78 offen offset:2048 sc1
    v_mfma_f32_16x16x32_bf16 v[164:167], v[84:87], a[20:23], v[164:167]
    ds_read_b128 v[116:119], v68 offset:25600
    s_waitcnt lgkmcnt(7)
    s_waitcnt vmcnt(14)
    v_mfma_f32_16x16x32_bf16 v[144:147], v[88:91], v[40:43], v[144:147]
    s_waitcnt vmcnt(13)
    v_mfma_f32_16x16x32_bf16 v[156:159], v[88:91], a[24:27], v[156:159]
    ds_read_b128 v[120:123], v68 offset:26624
    s_waitcnt lgkmcnt(7)
    v_mfma_f32_16x16x32_bf16 v[148:151], v[92:95], v[40:43], v[148:151]
    buffer_load_dwordx4 a[60:63], v71, s[32:35], s78 offen offset:3072 sc1
    v_mfma_f32_16x16x32_bf16 v[160:163], v[92:95], a[24:27], v[160:163]
    ds_read_b128 v[124:127], v68 offset:27648
    s_waitcnt lgkmcnt(7)
    v_mfma_f32_16x16x32_bf16 v[152:155], v[96:99], v[40:43], v[152:155]
    v_mfma_f32_16x16x32_bf16 v[164:167], v[96:99], a[24:27], v[164:167]
    ds_read_b128 v[128:131], v68 offset:28672
    s_waitcnt lgkmcnt(7)
    s_waitcnt vmcnt(13)
    v_mfma_f32_16x16x32_bf16 v[144:147], v[100:103], v[44:47], v[144:147]
    buffer_load_dwordx4 a[64:67], v79, s[32:35], s78 offen offset:0 sc1
    s_waitcnt vmcnt(13)
    v_mfma_f32_16x16x32_bf16 v[156:159], v[100:103], a[28:31], v[156:159]
    ds_read_b128 v[132:135], v68 offset:29696
    s_waitcnt lgkmcnt(7)
    v_mfma_f32_16x16x32_bf16 v[148:151], v[104:107], v[44:47], v[148:151]
    v_mfma_f32_16x16x32_bf16 v[160:163], v[104:107], a[28:31], v[160:163]
    ds_read_b128 v[136:139], v68 offset:30720
    s_waitcnt lgkmcnt(7)
    v_mfma_f32_16x16x32_bf16 v[152:155], v[108:111], v[44:47], v[152:155]
    buffer_load_dwordx4 a[68:71], v79, s[32:35], s78 offen offset:1024 sc1
    v_mfma_f32_16x16x32_bf16 v[164:167], v[108:111], a[28:31], v[164:167]
    ds_read_b128 v[140:143], v68 offset:31744
    s_waitcnt lgkmcnt(7)
    s_waitcnt vmcnt(13)
    v_mfma_f32_16x16x32_bf16 v[144:147], v[112:115], v[48:51], v[144:147]
    s_waitcnt vmcnt(12)
    v_mfma_f32_16x16x32_bf16 v[156:159], v[112:115], a[32:35], v[156:159]
    ds_read_b128 v[80:83], v68 offset:32768
    s_waitcnt lgkmcnt(7)
    v_mfma_f32_16x16x32_bf16 v[148:151], v[116:119], v[48:51], v[148:151]
    buffer_load_dwordx4 a[72:75], v79, s[32:35], s78 offen offset:2048 sc1
    v_mfma_f32_16x16x32_bf16 v[160:163], v[116:119], a[32:35], v[160:163]
    ds_read_b128 v[84:87], v68 offset:33792
    s_waitcnt lgkmcnt(7)
    v_mfma_f32_16x16x32_bf16 v[152:155], v[120:123], v[48:51], v[152:155]
    v_mfma_f32_16x16x32_bf16 v[164:167], v[120:123], a[32:35], v[164:167]
    ds_read_b128 v[88:91], v68 offset:34816
    s_waitcnt lgkmcnt(7)
    s_waitcnt vmcnt(12)
    v_mfma_f32_16x16x32_bf16 v[144:147], v[124:127], v[52:55], v[144:147]
    buffer_load_dwordx4 a[76:79], v79, s[32:35], s78 offen offset:3072 sc1
    s_waitcnt vmcnt(12)
    v_mfma_f32_16x16x32_bf16 v[156:159], v[124:127], a[36:39], v[156:159]
    ds_read_b128 v[92:95], v68 offset:35840
    s_waitcnt lgkmcnt(7)
    v_mfma_f32_16x16x32_bf16 v[148:151], v[128:131], v[52:55], v[148:151]
    v_mfma_f32_16x16x32_bf16 v[160:163], v[128:131], a[36:39], v[160:163]
    s_waitcnt lgkmcnt(6)
    v_mfma_f32_16x16x32_bf16 v[152:155], v[132:135], v[52:55], v[152:155]
    buffer_load_dwordx4 a[80:83], v78, s[32:35], s78 offen offset:0 sc1
    v_mfma_f32_16x16x32_bf16 v[164:167], v[132:135], a[36:39], v[164:167]
    s_waitcnt lgkmcnt(5)
    s_waitcnt vmcnt(12)
    v_mfma_f32_16x16x32_bf16 v[144:147], v[136:139], v[56:59], v[144:147]
    s_waitcnt vmcnt(11)
    v_mfma_f32_16x16x32_bf16 v[156:159], v[136:139], a[40:43], v[156:159]
    s_waitcnt lgkmcnt(4)
    v_mfma_f32_16x16x32_bf16 v[148:151], v[140:143], v[56:59], v[148:151]
    buffer_load_dwordx4 a[84:87], v78, s[32:35], s78 offen offset:1024 sc1
    v_mfma_f32_16x16x32_bf16 v[160:163], v[140:143], a[40:43], v[160:163]
    s_waitcnt lgkmcnt(3)
    v_mfma_f32_16x16x32_bf16 v[152:155], v[80:83], v[56:59], v[152:155]
    v_mfma_f32_16x16x32_bf16 v[164:167], v[80:83], a[40:43], v[164:167]
    s_waitcnt lgkmcnt(2)
    s_waitcnt vmcnt(11)
    v_mfma_f32_16x16x32_bf16 v[144:147], v[84:87], v[60:63], v[144:147]
    buffer_load_dwordx4 a[88:91], v78, s[32:35], s78 offen offset:2048 sc1
    s_waitcnt vmcnt(11)
    v_mfma_f32_16x16x32_bf16 v[156:159], v[84:87], a[44:47], v[156:159]
    s_waitcnt lgkmcnt(1)
    v_mfma_f32_16x16x32_bf16 v[148:151], v[88:91], v[60:63], v[148:151]
    v_mfma_f32_16x16x32_bf16 v[160:163], v[88:91], a[44:47], v[160:163]
    s_waitcnt lgkmcnt(0)
    v_mfma_f32_16x16x32_bf16 v[152:155], v[92:95], v[60:63], v[152:155]
    buffer_load_dwordx4 a[92:95], v78, s[32:35], s78 offen offset:3072 sc1
    v_mfma_f32_16x16x32_bf16 v[164:167], v[92:95], a[44:47], v[164:167]
    v_mfma_f32_16x16x16_bf16 v[144:147], v[176:177], v[64:65], v[144:147]
    v_mfma_f32_16x16x16_bf16 v[148:151], v[178:179], v[64:65], v[148:151]
    v_mfma_f32_16x16x16_bf16 v[152:155], v[180:181], v[64:65], v[152:155]
    v_mfma_f32_16x16x16_bf16 v[156:159], v[176:177], v[240:241], v[156:159]
    v_mfma_f32_16x16x16_bf16 v[160:163], v[178:179], v[240:241], v[160:163]
    v_mfma_f32_16x16x16_bf16 v[164:167], v[180:181], v[240:241], v[164:167]
    s_nop 2
    v_pk_mul_f32 v[144:145], v[144:145], v[4:5]
    v_pk_mul_f32 v[146:147], v[146:147], v[4:5]
    v_pk_mul_f32 v[148:149], v[148:149], v[4:5]
    v_pk_mul_f32 v[150:151], v[150:151], v[4:5]
    v_pk_mul_f32 v[152:153], v[152:153], v[4:5]
    v_pk_mul_f32 v[154:155], v[154:155], v[4:5]
    v_cmp_u_f32 vcc, v144, v156
    s_cbranch_vccnz L_p2_redo
L_p2_q_on:
    v_pk_mul_f32 v[156:157], v[156:157], v[242:243]
    v_pk_mul_f32 v[158:159], v[158:159], v[242:243]
    v_pk_mul_f32 v[160:161], v[160:161], v[242:243]
    v_pk_mul_f32 v[162:163], v[162:163], v[242:243]
    v_pk_mul_f32 v[164:165], v[164:165], v[242:243]
    v_pk_mul_f32 v[166:167], v[166:167], v[242:243]
    v_cvt_pk_bf16_f32 v80, v144, v145
    v_cvt_pk_bf16_f32 v81, v146, v147
    v_cvt_pk_bf16_f32 v82, v148, v149
    v_cvt_pk_bf16_f32 v83, v150, v151
    v_cvt_pk_bf16_f32 v84, v152, v153
    v_cvt_pk_bf16_f32 v85, v154, v155
    v_cvt_pk_bf16_f32 v88, v156, v157
    v_cvt_pk_bf16_f32 v89, v158, v159
    v_cvt_pk_bf16_f32 v90, v160, v161
    v_cvt_pk_bf16_f32 v91, v162, v163
    v_cvt_pk_bf16_f32 v92, v164, v165
    v_cvt_pk_bf16_f32 v93, v166, v167
    s_nop 0
    v_mfma_f32_16x16x32_bf16 v[168:171], v[12:15], v[80:83], 0
    v_mfma_f32_16x16x32_bf16 v[172:175], v[12:15], v[88:91], 0
    v_mfma_f32_16x16x16_bf16 v[168:171], v[12:13], v[84:85], v[168:171]
    v_mfma_f32_16x16x16_bf16 v[172:175], v[12:13], v[92:93], v[172:175]
    s_cmp_lg_u32 s61, 0
    s_cbranch_scc1 L_slow_13
    s_add_u32 s28, s3, 12288
    s_add_u32 s29, s17, 12288
    buffer_store_dwordx4 v[80:83], v68, s[32:35], s3 offen
    buffer_store_dwordx4 v[88:91], v68, s[32:35], s28 offen
    buffer_store_dwordx2 v[84:85], v68, s[32:35], s17 offen
    buffer_store_dwordx2 v[92:93], v68, s[32:35], s29 offen
    v_bfi_b32 v168, v69, v168, s54
    v_bfi_b32 v172, v69, v172, s54
    s_mov_b64 exec, s[50:51]
    buffer_store_dword v168, v244, s[32:35], s18 offen
    buffer_store_dword v172, v244, s[32:35], s18 offen offset:512
    s_mov_b64 exec, -1
    s_branch L_join_14
L_slow_13:
    s_add_u32 s28, s3, 12288
    s_add_u32 s29, s17, 12288
    buffer_store_dwordx4 v[80:83], v68, s[32:35], s3 offen sc1
    buffer_store_dwordx4 v[88:91], v68, s[32:35], s28 offen sc1
    buffer_store_dwordx2 v[84:85], v68, s[32:35], s17 offen sc1
    buffer_store_dwordx2 v[92:93], v68, s[32:35], s29 offen sc1
    v_bfi_b32 v168, v69, v168, s54
    v_bfi_b32 v172, v69, v172, s54
    s_mov_b64 exec, s[50:51]
    buffer_store_dword v168, v244, s[32:35], s18 offen sc1
    buffer_store_dword v172, v244, s[32:35], s18 offen offset:512 sc1
    s_mov_b64 exec, -1
L_join_14:
    buffer_load_dwordx4 a[96:99], v71, s[32:35], s79 offen offset:0 sc1
    buffer_load_dwordx4 a[100:103], v71, s[32:35], s79 offen offset:1024 sc1
    buffer_load_dwordx4 a[104:107], v71, s[32:35], s79 offen offset:2048 sc1
    buffer_load_dwordx4 a[108:111], v71, s[32:35], s79 offen offset:3072 sc1
    s_branch L_p2_done
L_p2_v:
    v_pk_add_f32 v[192:193], v[192:193], v[194:195]
    v_pk_add_f32 v[192:193], v[192:193], v[196:197]
    v_pk_add_f32 v[192:193], v[192:193], v[198:199]
    v_pk_add_f32 v[192:193], v[192:193], v[200:201]
    v_pk_add_f32 v[192:193], v[192:193], v[202:203]
    v_mul_f32 v204, 0x3b2aaaab, v192
    v_mul_f32 v205, 0x3b2aaaab, v193
    v_fma_f32 v205, -v204, v204, v205
    v_max_f32 v205, 0, v205
    v_add_f32 v205, 0x3727c5ac, v205
    v_rsq_f32 v205, v205
    s_nop 0
    v_mul_f32 v212, v204, v205
    ds_write_b32 v217, v205
    ds_write_b32 v217, v212 offset:256
    v_mov_b32 v67, v204
    v_mov_b32 v194, v204
    s_nop 1
    v_permlane16_swap_b32 v67, v194
    s_nop 0
    v_mov_b32 v196, v67
    v_mov_b32 v197, v194
    s_nop 1
    v_permlane32_swap_b32 v67, v196
    v_permlane32_swap_b32 v194, v197
    s_nop 0
    v_cvt_pk_bf16_f32 v5, -v67, -v67
    v_lshlrev_b32 v5, 16, v5
    v_sub_f32 v5, -v67, v5
    v_cvt_pk_bf16_f32 v5, -v67, v5
    v_cndmask_b32 v64, 0, v5, s[50:51]
    v_cndmask_b32 v65, 0, v5, s[50:51]
    v_cvt_pk_bf16_f32 v5, -v194, -v194
    v_lshlrev_b32 v5, 16, v5
    v_sub_f32 v5, -v194, v5
    v_cvt_pk_bf16_f32 v5, -v194, v5
    v_cndmask_b32 v240, 0, v5, s[50:51]
    v_cndmask_b32 v241, 0, v5, s[50:51]
    s_waitcnt lgkmcnt(0)
    ds_read_b128 v[232:235], v219 offset:0
    ds_read_b128 v[236:239], v219 offset:64
    s_waitcnt lgkmcnt(0)
L_p2_go1:
    ds_read_b128 v[80:83], v68 offset:0
    ds_read_b128 v[84:87], v68 offset:1024
    ds_read_b128 v[88:91], v68 offset:2048
    ds_read_b128 v[92:95], v68 offset:3072
    ds_read_b128 v[96:99], v68 offset:4096
    ds_read_b128 v[100:103], v68 offset:5120
    ds_read_b128 v[104:107], v68 offset:6144
    ds_read_b128 v[108:111], v68 offset:7168
    s_waitcnt lgkmcnt(7)
    s_waitcnt vmcnt(11)
    v_mfma_f32_16x16x32_bf16 v[144:147], v[16:19], v[80:83], 0
    buffer_load_dwordx4 v[40:43], v79, s[32:35], s76 offen offset:2048 sc1
    s_waitcnt vmcnt(11)
    v_mfma_f32_16x16x32_bf16 v[156:159], a[0:3], v[80:83], 0
    ds_read_b128 v[112:115], v68 offset:8192
    s_waitcnt lgkmcnt(7)
    v_mfma_f32_16x16x32_bf16 v[148:151], v[16:19], v[84:87], 0
    buffer_load_dwordx4 a[24:27], v79, s[32:35], s77 offen offset:2048 sc1
    v_mfma_f32_16x16x32_bf16 v[160:163], a[0:3], v[84:87], 0
    ds_read_b128 v[116:119], v68 offset:9216
    s_waitcnt lgkmcnt(7)
    v_mfma_f32_16x16x32_bf16 v[152:155], v[16:19], v[88:91], 0
    buffer_load_dwordx4 v[44:47], v79, s[32:35], s76 offen offset:3072 sc1
    v_mfma_f32_16x16x32_bf16 v[164:167], a[0:3], v[88:91], 0
    ds_read_b128 v[120:123], v68 offset:10240
    s_waitcnt lgkmcnt(7)
    s_waitcnt vmcnt(12)
    v_mfma_f32_16x16x32_bf16 v[144:147], v[20:23], v[92:95], v[144:147]
    buffer_load_dwordx4 a[28:31], v79, s[32:35], s77 offen offset:3072 sc1
    s_waitcnt vmcnt(12)
    v_mfma_f32_16x16x32_bf16 v[156:159], a[4:7], v[92:95], v[156:159]
    ds_read_b128 v[124:127], v68 offset:11264
    s_waitcnt lgkmcnt(7)
    v_mfma_f32_16x16x32_bf16 v[148:151], v[20:23], v[96:99], v[148:151]
    buffer_load_dwordx4 v[48:51], v78, s[32:35], s76 offen offset:0 sc1
    v_mfma_f32_16x16x32_bf16 v[160:163], a[4:7], v[96:99], v[160:163]
    ds_read_b128 v[128:131], v68 offset:12288
    s_waitcnt lgkmcnt(7)
    v_mfma_f32_16x16x32_bf16 v[152:155], v[20:23], v[100:103], v[152:155]
    buffer_load_dwordx4 a[32:35], v78, s[32:35], s77 offen offset:0 sc1
    v_mfma_f32_16x16x32_bf16 v[164:167], a[4:7], v[100:103], v[164:167]
    ds_read_b128 v[132:135], v68 offset:13312
    s_waitcnt lgkmcnt(7)
    s_waitcnt vmcnt(13)
    v_mfma_f32_16x16x32_bf16 v[144:147], v[24:27], v[104:107], v[144:147]
    buffer_load_dwordx4 v[52:55], v78, s[32:35], s76 offen offset:1024 sc1
    s_waitcnt vmcnt(13)
    v_mfma_f32_16x16x32_bf16 v[156:159], a[8:11], v[104:107], v[156:159]
    ds_read_b128 v[136:139], v68 offset:14336
    s_waitcnt lgkmcnt(7)
    v_mfma_f32_16x16x32_bf16 v[148:151], v[24:27], v[108:111], v[148:151]
    buffer_load_dwordx4 a[36:39], v78, s[32:35], s77 offen offset:1024 sc1
    v_mfma_f32_16x16x32_bf16 v[160:163], a[8:11], v[108:111], v[160:163]
    ds_read_b128 v[140:143], v68 offset:15360
    s_waitcnt lgkmcnt(7)
    v_mfma_f32_16x16x32_bf16 v[152:155], v[24:27], v[112:115], v[152:155]
    buffer_load_dwordx4 v[56:59], v78, s[32:35], s76 offen offset:2048 sc1
    v_mfma_f32_16x16x32_bf16 v[164:167], a[8:11], v[112:115], v[164:167]
    ds_read_b128 v[80:83], v68 offset:16384
    s_waitcnt lgkmcnt(7)
    s_waitcnt vmcnt(14)
    v_mfma_f32_16x16x32_bf16 v[144:147], v[28:31], v[116:119], v[144:147]
    buffer_load_dwordx4 a[40:43], v78, s[32:35], s77 offen offset:2048 sc1
    s_waitcnt vmcnt(14)
    v_mfma_f32_16x16x32_bf16 v[156:159], a[12:15], v[116:119], v[156:159]
    ds_read_b128 v[84:87], v68 offset:17408
    s_waitcnt lgkmcnt(7)
    v_mfma_f32_16x16x32_bf16 v[148:151], v[28:31], v[120:123], v[148:151]
    buffer_load_dwordx4 v[60:63], v78, s[32:35], s76 offen offset:3072 sc1
    v_mfma_f32_16x16x32_bf16 v[160:163], a[12:15], v[120:123], v[160:163]
    ds_read_b128 v[88:91], v68 offset:18432
    s_waitcnt lgkmcnt(7)
    v_mfma_f32_16x16x32_bf16 v[152:155], v[28:31], v[124:127], v[152:155]
    buffer_load_dwordx4 a[44:47], v78, s[32:35], s77 offen offset:3072 sc1
    v_mfma_f32_16x16x32_bf16 v[164:167], a[12:15], v[124:127], v[164:167]
    ds_read_b128 v[92:95], v68 offset:19456
    s_waitcnt lgkmcnt(7)
    s_waitcnt vmcnt(15)
    v_mfma_f32_16x16x32_bf16 v[144:147], v[32:35], v[128:131], v[144:147]
    s_waitcnt vmcnt(14)
    v_mfma_f32_16x16x32_bf16 v[156:159], a[16:19], v[128:131], v[156:159]
    ds_read_b128 v[96:99], v68 offset:20480
    s_waitcnt lgkmcnt(7)
    v_mfma_f32_16x16x32_bf16 v[148:151], v[32:35], v[132:135], v[148:151]
    buffer_load_dwordx4 a[48:51], v71, s[32:35], s78 offen offset:0 sc1
    v_mfma_f32_16x16x32_bf16 v[160:163], a[16:19], v[132:135], v[160:163]
    ds_read_b128 v[100:103], v68 offset:21504
    s_waitcnt lgkmcnt(7)
    v_mfma_f32_16x16x32_bf16 v[152:155], v[32:35], v[136:139], v[152:155]
    v_mfma_f32_16x16x32_bf16 v[164:167], a[16:19], v[136:139], v[164:167]
    ds_read_b128 v[104:107], v68 offset:22528
    s_waitcnt lgkmcnt(7)
    s_waitcnt vmcnt(14)
    v_mfma_f32_16x16x32_bf16 v[144:147], v[36:39], v[140:143], v[144:147]
    buffer_load_dwordx4 a[52:55], v71, s[32:35], s78 offen offset:1024 sc1
    s_waitcnt vmcnt(14)
    v_mfma_f32_16x16x32_bf16 v[156:159], a[20:23], v[140:143], v[156:159]
    ds_read_b128 v[108:111], v68 offset:23552
    s_waitcnt lgkmcnt(7)
    v_mfma_f32_16x16x32_bf16 v[148:151], v[36:39], v[80:83], v[148:151]
    v_mfma_f32_16x16x32_bf16 v[160:163], a[20:23], v[80:83], v[160:163]
    ds_read_b128 v[112:115], v68 offset:24576
    s_waitcnt lgkmcnt(7)
    v_mfma_f32_16x16x32_bf16 v[152:155], v[36:39], v[84:87], v[152:155]
    buffer_load_dwordx4 a[56:59], v71, s[32:35], s78 offen offset:2048 sc1
    v_mfma_f32_16x16x32_bf16 v[164:167], a[20:23], v[84:87], v[164:167]
    ds_read_b128 v[116:119], v68 offset:25600
    s_waitcnt lgkmcnt(7)
    s_waitcnt vmcnt(14)
    v_mfma_f32_16x16x32_bf16 v[144:147], v[40:43], v[88:91], v[144:147]
    s_waitcnt vmcnt(13)
    v_mfma_f32_16x16x32_bf16 v[156:159], a[24:27], v[88:91], v[156:159]
    ds_read_b128 v[120:123], v68 offset:26624
    s_waitcnt lgkmcnt(7)
    v_mfma_f32_16x16x32_bf16 v[148:151], v[40:43], v[92:95], v[148:151]
    buffer_load_dwordx4 a[60:63], v71, s[32:35], s78 offen offset:3072 sc1
    v_mfma_f32_16x16x32_bf16 v[160:163], a[24:27], v[92:95], v[160:163]
    ds_read_b128 v[124:127], v68 offset:27648
    s_waitcnt lgkmcnt(7)
    v_mfma_f32_16x16x32_bf16 v[152:155], v[40:43], v[96:99], v[152:155]
    v_mfma_f32_16x16x32_bf16 v[164:167], a[24:27], v[96:99], v[164:167]
    ds_read_b128 v[128:131], v68 offset:28672
    s_waitcnt lgkmcnt(7)
    s_waitcnt vmcnt(13)
    v_mfma_f32_16x16x32_bf16 v[144:147], v[44:47], v[100:103], v[144:147]
    buffer_load_dwordx4 a[64:67], v79, s[32:35], s78 offen offset:0 sc1
    s_waitcnt vmcnt(13)
    v_mfma_f32_16x16x32_bf16 v[156:159], a[28:31], v[100:103], v[156:159]
    ds_read_b128 v[132:135], v68 offset:29696
    s_waitcnt lgkmcnt(7)
    v_mfma_f32_16x16x32_bf16 v[148:151], v[44:47], v[104:107], v[148:151]
    v_mfma_f32_16x16x32_bf16 v[160:163], a[28:31], v[104:107], v[160:163]
    ds_read_b128 v[136:139], v68 offset:30720
    s_waitcnt lgkmcnt(7)
    v_mfma_f32_16x16x32_bf16 v[152:155], v[44:47], v[108:111], v[152:155]
    buffer_load_dwordx4 a[68:71], v79, s[32:35], s78 offen offset:1024 sc1
    v_mfma_f32_16x16x32_bf16 v[164:167], a[28:31], v[108:111], v[164:167]
    ds_read_b128 v[140:143], v68 offset:31744
    s_waitcnt lgkmcnt(7)
    s_waitcnt vmcnt(13)
    v_mfma_f32_16x16x32_bf16 v[144:147], v[48:51], v[112:115], v[144:147]
    s_waitcnt vmcnt(12)
    v_mfma_f32_16x16x32_bf16 v[156:159], a[32:35], v[112:115], v[156:159]
    ds_read_b128 v[80:83], v68 offset:32768
    s_waitcnt lgkmcnt(7)
    v_mfma_f32_16x16x32_bf16 v[148:151], v[48:51], v[116:119], v[148:151]
    buffer_load_dwordx4 a[72:75], v79, s[32:35], s78 offen offset:2048 sc1
    v_mfma_f32_16x16x32_bf16 v[160:163], a[32:35], v[116:119], v[160:163]
    ds_read_b128 v[84:87], v68 offset:33792
    s_waitcnt lgkmcnt(7)
    v_mfma_f32_16x16x32_bf16 v[152:155], v[48:51], v[120:123], v[152:155]
    v_mfma_f32_16x16x32_bf16 v[164:167], a[32:35], v[120:123], v[164:167]
    ds_read_b128 v[88:91], v68 offset:34816
    s_waitcnt lgkmcnt(7)
    s_waitcnt vmcnt(12)
    v_mfma_f32_16x16x32_bf16 v[144:147], v[52:55], v[124:127], v[144:147]
    buffer_load_dwordx4 a[76:79], v79, s[32:35], s78 offen offset:3072 sc1
    s_waitcnt vmcnt(12)
    v_mfma_f32_16x16x32_bf16 v[156:159], a[36:39], v[124:127], v[156:159]
    ds_read_b128 v[92:95], v68 offset:35840
    s_waitcnt lgkmcnt(7)
    v_mfma_f32_16x16x32_bf16 v[148:151], v[52:55], v[128:131], v[148:151]
    v_mfma_f32_16x16x32_bf16 v[160:163], a[36:39], v[128:131], v[160:163]
    s_waitcnt lgkmcnt(6)
    v_mfma_f32_16x16x32_bf16 v[152:155], v[52:55], v[132:135], v[152:155]
    buffer_load_dwordx4 a[80:83], v78, s[32:35], s78 offen offset:0 sc1
    v_mfma_f32_16x16x32_bf16 v[164:167], a[36:39], v[132:135], v[164:167]
    s_waitcnt lgkmcnt(5)
    s_waitcnt vmcnt(12)
    v_mfma_f32_16x16x32_bf16 v[144:147], v[56:59], v[136:139], v[144:147]
    s_waitcnt vmcnt(11)
    v_mfma_f32_16x16x32_bf16 v[156:159], a[40:43], v[136:139], v[156:159]
    s_waitcnt lgkmcnt(4)
    v_mfma_f32_16x16x32_bf16 v[148:151], v[56:59], v[140:143], v[148:151]
    buffer_load_dwordx4 a[84:87], v78, s[32:35], s78 offen offset:1024 sc1
    v_mfma_f32_16x16x32_bf16 v[160:163], a[40:43], v[140:143], v[160:163]
    s_waitcnt lgkmcnt(3)
    v_mfma_f32_16x16x32_bf16 v[152:155], v[56:59], v[80:83], v[152:155]
    v_mfma_f32_16x16x32_bf16 v[164:167], a[40:43], v[80:83], v[164:167]
    s_waitcnt lgkmcnt(2)
    s_waitcnt vmcnt(11)
    v_mfma_f32_16x16x32_bf16 v[144:147], v[60:63], v[84:87], v[144:147]
    buffer_load_dwordx4 a[88:91], v78, s[32:35], s78 offen offset:2048 sc1
    s_waitcnt vmcnt(11)
    v_mfma_f32_16x16x32_bf16 v[156:159], a[44:47], v[84:87], v[156:159]
    s_waitcnt lgkmcnt(1)
    v_mfma_f32_16x16x32_bf16 v[148:151], v[60:63], v[88:91], v[148:151]
    v_mfma_f32_16x16x32_bf16 v[160:163], a[44:47], v[88:91], v[160:163]
    s_waitcnt lgkmcnt(0)
    v_mfma_f32_16x16x32_bf16 v[152:155], v[60:63], v[92:95], v[152:155]
    buffer_load_dwordx4 a[92:95], v78, s[32:35], s78 offen offset:3072 sc1
    v_mfma_f32_16x16x32_bf16 v[164:167], a[44:47], v[92:95], v[164:167]
    v_mfma_f32_16x16x16_bf16 v[144:147], v[64:65], v[176:177], v[144:147]
    v_mfma_f32_16x16x16_bf16 v[148:151], v[64:65], v[178:179], v[148:151]
    v_mfma_f32_16x16x16_bf16 v[152:155], v[64:65], v[180:181], v[152:155]
    v_mfma_f32_16x16x16_bf16 v[156:159], v[240:241], v[176:177], v[156:159]
    v_mfma_f32_16x16x16_bf16 v[160:163], v[240:241], v[178:179], v[160:163]
    v_mfma_f32_16x16x16_bf16 v[164:167], v[240:241], v[180:181], v[164:167]
    s_nop 2
    v_pk_mul_f32 v[144:145], v[144:145], v[232:233]
    v_pk_mul_f32 v[146:147], v[146:147], v[234:235]
    v_pk_mul_f32 v[148:149], v[148:149], v[232:233]
    v_pk_mul_f32 v[150:151], v[150:151], v[234:235]
    v_pk_mul_f32 v[152:153], v[152:153], v[232:233]
    v_pk_mul_f32 v[154:155], v[154:155], v[234:235]
    v_pk_add_f32 v[168:169], v[144:145], v[156:157]
    v_pk_add_f32 v[170:171], v[146:147], v[158:159]
    v_pk_add_f32 v[168:169], v[168:169], v[170:171]
    v_cmp_u_f32 vcc, v168, v169
    s_cbranch_vccnz L_p2_redo
L_p2_v_on:
    v_pk_mul_f32 v[156:157], v[156:157], v[236:237]
    v_pk_mul_f32 v[158:159], v[158:159], v[238:239]
    v_pk_mul_f32 v[160:161], v[160:161], v[236:237]
    v_pk_mul_f32 v[162:163], v[162:163], v[238:239]
    v_pk_mul_f32 v[164:165], v[164:165], v[236:237]
    v_pk_mul_f32 v[166:167], v[166:167], v[238:239]
    v_cvt_pk_bf16_f32 v80, v144, v145
    v_cvt_pk_bf16_f32 v81, v146, v147
    v_cvt_pk_bf16_f32 v82, v156, v157
    v_cvt_pk_bf16_f32 v83, v158, v159
    v_cvt_pk_bf16_f32 v84, v148, v149
    v_cvt_pk_bf16_f32 v85, v150, v151
    v_cvt_pk_bf16_f32 v86, v160, v161
    v_cvt_pk_bf16_f32 v87, v162, v163
    v_cvt_pk_bf16_f32 v88, v152, v153
    v_cvt_pk_bf16_f32 v89, v154, v155
    v_cvt_pk_bf16_f32 v90, v164, v165
    v_cvt_pk_bf16_f32 v91, v166, v167
    s_cmp_lg_u32 s61, 0
    s_cbranch_scc1 L_slow_15
    buffer_store_dwordx4 v[80:83], v68, s[32:35], s3 offen
    buffer_store_dwordx4 v[84:87], v68, s[32:35], s3 offen offset:1024
    buffer_store_dwordx4 v[88:91], v68, s[32:35], s17 offen offset:2048
    s_branch L_join_16
L_slow_15:
    buffer_store_dwordx4 v[80:83], v68, s[32:35], s3 offen sc1
    buffer_store_dwordx4 v[84:87], v68, s[32:35], s3 offen offset:1024 sc1
    buffer_store_dwordx4 v[88:91], v68, s[32:35], s17 offen offset:2048 sc1
L_join_16:
    buffer_load_dwordx4 a[96:99], v71, s[32:35], s79 offen offset:0 sc1
    buffer_load_dwordx4 a[100:103], v71, s[32:35], s79 offen offset:1024 sc1
    buffer_load_dwordx4 a[104:107], v71, s[32:35], s79 offen offset:2048 sc1
    buffer_load_dwordx4 a[108:111], v71, s[32:35], s79 offen offset:3072 sc1
    s_waitcnt vmcnt(4)
    s_mov_b64 exec, 1
    s_cmp_lg_u32 s61, 0
    s_cbranch_scc1 L_slow_17
    buffer_store_dword v229, v228, s[32:35], s19 offen
    s_branch L_join_18
L_slow_17:
    buffer_store_dword v229, v228, s[32:35], s19 offen sc1
L_join_18:
    s_mov_b64 exec, -1
L_p2_done:
    ds_read_b128 v[192:195], v219 offset:0
    ds_read_b128 v[232:235], v219 offset:256
    ds_read_b128 v[196:199], v219 offset:64
    ds_read_b128 v[236:239], v219 offset:320
    ds_read_b128 v[200:203], v219 offset:128
    ds_read_b128 v[240:243], v219 offset:384
    ds_read_b128 v[204:207], v219 offset:192
    ds_read_b128 v[244:247], v219 offset:448
    s_mov_b32 s31, 40000
L_e3:
    buffer_load_dwordx2 v[252:253], v73, s[32:35], s1 offen offset:0 sc1
    buffer_load_dwordx2 v[254:255], v73, s[32:35], s1 offen offset:512 sc1
    s_waitcnt vmcnt(0)
    v_xor_b32 v252, s54, v252
    v_xor_b32 v253, s54, v253
    v_xor_b32 v254, s54, v254
    v_xor_b32 v255, s54, v255
    v_or3_b32 v4, v252, v253, v254
    v_or_b32 v4, v4, v255
    v_and_b32 v4, 0xff, v4
    v_cmp_ne_u32 vcc, 0, v4
    s_cbranch_vccz L_e3ok
    s_sub_u32 s31, s31, 1
    s_cbranch_scc0 L_e3
L_e3ok:
    s_add_u32 m0, s8, 0
    s_nop 0
    buffer_load_dwordx4 v68, s[32:35], s0 offen offset:0 sc1 lds
    s_add_u32 m0, s9, 0
    s_nop 0
    buffer_load_dwordx4 v68, s[32:35], s0 offen offset:1024 sc1 lds
    s_add_u32 m0, s10, 0
    s_nop 0
    buffer_load_dwordx4 v68, s[32:35], s0 offen offset:2048 sc1 lds
    s_add_u32 m0, s8, 12288
    s_nop 0
    buffer_load_dwordx4 v68, s[32:35], s5 offen offset:0 sc1 lds
    s_add_u32 m0, s9, 12288
    s_nop 0
    buffer_load_dwordx4 v68, s[32:35], s5 offen offset:1024 sc1 lds
    s_add_u32 m0, s10, 12288
    s_nop 0
    buffer_load_dwordx4 v68, s[32:35], s5 offen offset:2048 sc1 lds
    buffer_load_dword v11, v191, s[32:35], s4 offen sc1
    s_waitcnt lgkmcnt(0)
    v_add_f32 v186, v252, v253
    v_add_f32 v187, v254, v255
    v_mov_b32 v248, v186
    v_mov_b32 v249, v187
    s_nop 0
    v_permlane16_swap_b32 v186, v248
    v_permlane16_swap_b32 v187, v249
    v_add_f32 v186, v186, v248
    v_add_f32 v187, v187, v249
    v_mov_b32 v248, v186
    v_mov_b32 v249, v187
    s_nop 0
    v_permlane32_swap_b32 v186, v248
    v_permlane32_swap_b32 v187, v249
    v_add_f32 v250, v186, v248
    v_add_f32 v251, v186, v248
    v_add_f32 v252, v187, v249
    v_add_f32 v253, v187, v249
    v_pk_mul_f32 v[80:81], v[232:233], v[250:251]
    v_pk_mul_f32 v[82:83], v[234:235], v[250:251]
    v_pk_mul_f32 v[84:85], v[236:237], v[250:251]
    v_pk_mul_f32 v[86:87], v[238:239], v[250:251]
    v_pk_mul_f32 v[88:89], v[240:241], v[250:251]
    v_pk_mul_f32 v[90:91], v[242:243], v[250:251]
    v_pk_mul_f32 v[92:93], v[244:245], v[250:251]
    v_pk_mul_f32 v[94:95], v[246:247], v[250:251]
    v_pk_mul_f32 v[96:97], v[232:233], v[252:253]
    v_pk_mul_f32 v[98:99], v[234:235], v[252:253]
    v_pk_mul_f32 v[100:101], v[236:237], v[252:253]
    v_pk_mul_f32 v[102:103], v[238:239], v[252:253]
    v_pk_mul_f32 v[104:105], v[240:241], v[252:253]
    v_pk_mul_f32 v[106:107], v[242:243], v[252:253]
    v_pk_mul_f32 v[108:109], v[244:245], v[252:253]
    v_pk_mul_f32 v[110:111], v[246:247], v[252:253]
    s_waitcnt vmcnt(4)
    s_barrier
    ds_read_b128 v[112:115], v74 offset:0
    ds_read_b128 v[116:119], v74 offset:1024
    ds_read_b128 v[120:123], v74 offset:2048
    ds_read_b128 v[124:127], v74 offset:3072
    ds_read_b128 v[128:131], v74 offset:4096
    ds_read_b128 v[132:135], v74 offset:5120
    s_waitcnt lgkmcnt(5)
    v_mfma_f32_16x16x32_bf16 v[144:147], v[16:19], v[112:115], 0
    buffer_load_dwordx4 a[112:115], v79, s[32:35], s79 offen offset:0 sc1
    v_mfma_f32_16x16x32_bf16 v[148:151], a[0:3], v[112:115], 0
    ds_read_b128 v[136:139], v74 offset:6144
    s_waitcnt lgkmcnt(5)
    v_mfma_f32_16x16x32_bf16 v[144:147], v[20:23], v[116:119], v[144:147]
    buffer_load_dwordx4 a[116:119], v79, s[32:35], s79 offen offset:1024 sc1
    v_mfma_f32_16x16x32_bf16 v[148:151], a[4:7], v[116:119], v[148:151]
    ds_read_b128 v[140:143], v74 offset:7168
    s_waitcnt lgkmcnt(5)
    v_mfma_f32_16x16x32_bf16 v[144:147], v[24:27], v[120:123], v[144:147]
    buffer_load_dwordx4 a[120:123], v79, s[32:35], s79 offen offset:2048 sc1
    v_mfma_f32_16x16x32_bf16 v[148:151], a[8:11], v[120:123], v[148:151]
    ds_read_b128 v[112:115], v74 offset:8192
    s_waitcnt lgkmcnt(5)
    v_mfma_f32_16x16x32_bf16 v[144:147], v[28:31], v[124:127], v[144:147]
    buffer_load_dwordx4 a[124:127], v79, s[32:35], s79 offen offset:3072 sc1
    v_mfma_f32_16x16x32_bf16 v[148:151], a[12:15], v[124:127], v[148:151]
    ds_read_b128 v[116:119], v74 offset:9216
    s_waitcnt lgkmcnt(5)
    v_mfma_f32_16x16x32_bf16 v[144:147], v[32:35], v[128:131], v[144:147]
    buffer_load_dwordx4 a[128:131], v78, s[32:35], s79 offen offset:0 sc1
    v_mfma_f32_16x16x32_bf16 v[148:151], a[16:19], v[128:131], v[148:151]
    ds_read_b128 v[120:123], v74 offset:10240
    s_waitcnt lgkmcnt(5)
    v_mfma_f32_16x16x32_bf16 v[144:147], v[36:39], v[132:135], v[144:147]
    buffer_load_dwordx4 a[132:135], v78, s[32:35], s79 offen offset:1024 sc1
    v_mfma_f32_16x16x32_bf16 v[148:151], a[20:23], v[132:135], v[148:151]
    ds_read_b128 v[124:127], v74 offset:11264
    s_waitcnt lgkmcnt(5)
    v_mfma_f32_16x16x32_bf16 v[144:147], v[40:43], v[136:139], v[144:147]
    buffer_load_dwordx4 a[136:139], v78, s[32:35], s79 offen offset:2048 sc1
    v_mfma_f32_16x16x32_bf16 v[148:151], a[24:27], v[136:139], v[148:151]
    s_waitcnt vmcnt(7)
    s_barrier
    ds_read_b128 v[128:131], v74 offset:12288
    s_waitcnt lgkmcnt(5)
    v_mfma_f32_16x16x32_bf16 v[144:147], v[44:47], v[140:143], v[144:147]
    buffer_load_dwordx4 a[140:143], v78, s[32:35], s79 offen offset:3072 sc1
    v_mfma_f32_16x16x32_bf16 v[148:151], a[28:31], v[140:143], v[148:151]
    ds_read_b128 v[132:135], v74 offset:13312
    s_waitcnt lgkmcnt(5)
    v_mfma_f32_16x16x32_bf16 v[144:147], v[48:51], v[112:115], v[144:147]
    v_mfma_f32_16x16x32_bf16 v[148:151], a[32:35], v[112:115], v[148:151]
    ds_read_b128 v[136:139], v74 offset:14336
    s_waitcnt lgkmcnt(5)
    v_mfma_f32_16x16x32_bf16 v[144:147], v[52:55], v[116:119], v[144:147]
    s_waitcnt vmcnt(8)
    v_cmp_ne_u32 vcc, s23, v11
    s_cbranch_vccz L_v_ok
    s_mov_b32 s31, 40000
L_pv_19:
    buffer_load_dword v11, v191, s[32:35], s4 offen sc1
    s_waitcnt vmcnt(0)
    v_cmp_ne_u32 vcc, s23, v11
    s_cbranch_vccz L_pv_ok_20
    s_sub_u32 s31, s31, 1
    s_cbranch_scc0 L_pv_19
L_pv_ok_20:
L_v_ok:
    buffer_load_dwordx4 a[144:147], v68, s[32:35], s72 offen offset:0 sc1
    v_mfma_f32_16x16x32_bf16 v[148:151], a[36:39], v[116:119], v[148:151]
    ds_read_b128 v[140:143], v74 offset:15360
    s_waitcnt lgkmcnt(5)
    v_mfma_f32_16x16x32_bf16 v[144:147], v[56:59], v[120:123], v[144:147]
    v_mfma_f32_16x16x32_bf16 v[148:151], a[40:43], v[120:123], v[148:151]
    buffer_load_dwordx4 a[148:151], v68, s[32:35], s72 offen offset:1024 sc1
    ds_read_b128 v[112:115], v74 offset:16384
    s_waitcnt lgkmcnt(5)
    v_mfma_f32_16x16x32_bf16 v[144:147], v[60:63], v[124:127], v[144:147]
    v_mfma_f32_16x16x32_bf16 v[148:151], a[44:47], v[124:127], v[148:151]
    ds_read_b128 v[116:119], v74 offset:17408
    s_waitcnt lgkmcnt(5)
    v_mfma_f32_16x16x32_bf16 v[160:163], v[16:19], v[128:131], 0
    buffer_load_dwordx4 a[152:155], v68, s[32:35], s72 offen offset:2048 sc1
    v_mfma_f32_16x16x32_bf16 v[164:167], a[0:3], v[128:131], 0
    ds_read_b128 v[120:123], v74 offset:18432
    s_waitcnt lgkmcnt(5)
    v_mfma_f32_16x16x32_bf16 v[160:163], v[20:23], v[132:135], v[160:163]
    v_mfma_f32_16x16x32_bf16 v[164:167], a[4:7], v[132:135], v[164:167]
    buffer_load_dwordx4 a[156:159], v68, s[32:35], s72 offen offset:3072 sc1
    ds_read_b128 v[124:127], v74 offset:19456
    s_waitcnt lgkmcnt(5)
    v_mfma_f32_16x16x32_bf16 v[160:163], v[24:27], v[136:139], v[160:163]
    v_mfma_f32_16x16x32_bf16 v[164:167], a[8:11], v[136:139], v[164:167]
    ds_read_b128 v[128:131], v74 offset:20480
    s_waitcnt lgkmcnt(5)
    v_mfma_f32_16x16x32_bf16 v[160:163], v[28:31], v[140:143], v[160:163]
    v_mfma_f32_16x16x32_bf16 v[164:167], a[12:15], v[140:143], v[164:167]
    buffer_load_dwordx4 a[160:163], v216, s[32:35], s72 offen offset:0 sc1
    ds_read_b128 v[132:135], v74 offset:21504
    s_waitcnt lgkmcnt(5)
    v_mfma_f32_16x16x32_bf16 v[160:163], v[32:35], v[112:115], v[160:163]
    v_mfma_f32_16x16x32_bf16 v[164:167], a[16:19], v[112:115], v[164:167]
    ds_read_b128 v[136:139], v74 offset:22528
    s_waitcnt lgkmcnt(5)
    v_mfma_f32_16x16x32_bf16 v[160:163], v[36:39], v[116:119], v[160:163]
    buffer_load_dwordx4 a[164:167], v216, s[32:35], s72 offen offset:1024 sc1
    v_mfma_f32_16x16x32_bf16 v[164:167], a[20:23], v[116:119], v[164:167]
    ds_read_b128 v[140:143], v74 offset:23552
    s_waitcnt lgkmcnt(5)
    v_mfma_f32_16x16x32_bf16 v[160:163], v[40:43], v[120:123], v[160:163]
    v_mfma_f32_16x16x32_bf16 v[164:167], a[24:27], v[120:123], v[164:167]
    buffer_load_dwordx4 a[168:171], v68, s[32:35], s75 offen offset:0 sc1
    ds_read_b128 v[112:115], v74 offset:0
    s_waitcnt lgkmcnt(5)
    v_mfma_f32_16x16x32_bf16 v[160:163], v[44:47], v[124:127], v[160:163]
    v_mfma_f32_16x16x32_bf16 v[164:167], a[28:31], v[124:127], v[164:167]
    ds_read_b128 v[116:119], v74 offset:1024
    s_waitcnt lgkmcnt(5)
    v_mfma_f32_16x16x32_bf16 v[160:163], v[48:51], v[128:131], v[160:163]
    v_mfma_f32_16x16x32_bf16 v[164:167], a[32:35], v[128:131], v[164:167]
    buffer_load_dwordx4 a[172:175], v68, s[32:35], s75 offen offset:1024 sc1
    ds_read_b128 v[120:123], v74 offset:2048
    s_waitcnt lgkmcnt(5)
    v_mfma_f32_16x16x32_bf16 v[160:163], v[52:55], v[132:135], v[160:163]
    v_mfma_f32_16x16x32_bf16 v[164:167], a[36:39], v[132:135], v[164:167]
    ds_read_b128 v[124:127], v74 offset:3072
    s_waitcnt lgkmcnt(5)
    v_mfma_f32_16x16x32_bf16 v[160:163], v[56:59], v[136:139], v[160:163]
    buffer_load_dwordx4 a[176:179], v68, s[32:35], s75 offen offset:2048 sc1
    v_mfma_f32_16x16x32_bf16 v[164:167], a[40:43], v[136:139], v[164:167]
    ds_read_b128 v[128:131], v74 offset:4096
    s_waitcnt lgkmcnt(5)
    v_mfma_f32_16x16x32_bf16 v[160:163], v[60:63], v[140:143], v[160:163]
    v_mfma_f32_16x16x32_bf16 v[164:167], a[44:47], v[140:143], v[164:167]
    buffer_load_dwordx4 a[180:183], v68, s[32:35], s75 offen offset:3072 sc1
    ds_read_b128 v[132:135], v74 offset:5120
    s_waitcnt lgkmcnt(5)
    v_mfma_f32_16x16x32_bf16 v[152:155], a[48:51], v[112:115], 0
    v_mfma_f32_16x16x32_bf16 v[156:159], a[96:99], v[112:115], 0
    ds_read_b128 v[136:139], v74 offset:6144
    s_waitcnt lgkmcnt(5)
    v_mfma_f32_16x16x32_bf16 v[152:155], a[52:55], v[116:119], v[152:155]
    buffer_load_dwordx4 a[184:187], v216, s[32:35], s75 offen offset:0 sc1
    v_mfma_f32_16x16x32_bf16 v[156:159], a[100:103], v[116:119], v[156:159]
    ds_read_b128 v[140:143], v74 offset:7168
    s_waitcnt lgkmcnt(5)
    v_mfma_f32_16x16x32_bf16 v[152:155], a[56:59], v[120:123], v[152:155]
    v_mfma_f32_16x16x32_bf16 v[156:159], a[104:107], v[120:123], v[156:159]
    ds_read_b128 v[112:115], v74 offset:8192
    s_waitcnt lgkmcnt(5)
    v_mfma_f32_16x16x32_bf16 v[152:155], a[60:63], v[124:127], v[152:155]
    buffer_load_dwordx4 a[188:191], v216, s[32:35], s75 offen offset:1024 sc1
    v_mfma_f32_16x16x32_bf16 v[156:159], a[108:111], v[124:127], v[156:159]
    ds_read_b128 v[116:119], v74 offset:9216
    s_waitcnt lgkmcnt(5)
    v_mfma_f32_16x16x32_bf16 v[152:155], a[64:67], v[128:131], v[152:155]
    s_waitcnt vmcnt(19)
    v_mfma_f32_16x16x32_bf16 v[156:159], a[112:115], v[128:131], v[156:159]
    buffer_load_dwordx4 v[220:223], v190, s[32:35], s80 offen sc1
    ds_read_b128 v[120:123], v74 offset:10240
    s_waitcnt lgkmcnt(5)
    v_mfma_f32_16x16x32_bf16 v[152:155], a[68:71], v[132:135], v[152:155]
    s_waitcnt vmcnt(19)
    v_mfma_f32_16x16x32_bf16 v[156:159], a[116:119], v[132:135], v[156:159]
    ds_read_b128 v[124:127], v74 offset:11264
    s_waitcnt lgkmcnt(5)
    v_mfma_f32_16x16x32_bf16 v[152:155], a[72:75], v[136:139], v[152:155]
    buffer_load_dwordx4 v[224:227], v190, s[32:35], s81 offen offset:2048 sc1
    s_waitcnt vmcnt(19)
    v_mfma_f32_16x16x32_bf16 v[156:159], a[120:123], v[136:139], v[156:159]
    ds_read_b128 v[128:131], v74 offset:12288
    s_waitcnt lgkmcnt(5)
    v_mfma_f32_16x16x32_bf16 v[152:155], a[76:79], v[140:143], v[152:155]
    s_waitcnt vmcnt(18)
    v_mfma_f32_16x16x32_bf16 v[156:159], a[124:127], v[140:143], v[156:159]
    ds_read_b128 v[132:135], v74 offset:13312
    s_waitcnt lgkmcnt(5)
    v_mfma_f32_16x16x32_bf16 v[152:155], a[80:83], v[112:115], v[152:155]
    s_waitcnt vmcnt(17)
    v_mfma_f32_16x16x32_bf16 v[156:159], a[128:131], v[112:115], v[156:159]
    ds_read_b128 v[136:139], v74 offset:14336
    s_waitcnt lgkmcnt(5)
    v_mfma_f32_16x16x32_bf16 v[152:155], a[84:87], v[116:119], v[152:155]
    s_waitcnt vmcnt(16)
    v_mfma_f32_16x16x32_bf16 v[156:159], a[132:135], v[116:119], v[156:159]
    ds_read_b128 v[140:143], v74 offset:15360
    s_waitcnt lgkmcnt(5)
    v_mfma_f32_16x16x32_bf16 v[152:155], a[88:91], v[120:123], v[152:155]
    s_waitcnt vmcnt(15)
    v_mfma_f32_16x16x32_bf16 v[156:159], a[136:139], v[120:123], v[156:159]
    ds_read_b128 v[112:115], v74 offset:16384
    s_waitcnt lgkmcnt(5)
    v_mfma_f32_16x16x32_bf16 v[152:155], a[92:95], v[124:127], v[152:155]
    s_waitcnt vmcnt(14)
    v_mfma_f32_16x16x32_bf16 v[156:159], a[140:143], v[124:127], v[156:159]
    ds_read_b128 v[116:119], v74 offset:17408
    s_waitcnt lgkmcnt(5)
    v_mfma_f32_16x16x32_bf16 v[168:171], a[48:51], v[128:131], 0
    v_mfma_f32_16x16x32_bf16 v[172:175], a[96:99], v[128:131], 0
    ds_read_b128 v[120:123], v74 offset:18432
    s_waitcnt lgkmcnt(5)
    v_mfma_f32_16x16x32_bf16 v[168:171], a[52:55], v[132:135], v[168:171]
    v_mfma_f32_16x16x32_bf16 v[172:175], a[100:103], v[132:135], v[172:175]
    ds_read_b128 v[124:127], v74 offset:19456
    s_waitcnt lgkmcnt(5)
    v_mfma_f32_16x16x32_bf16 v[168:171], a[56:59], v[136:139], v[168:171]
    v_mfma_f32_16x16x32_bf16 v[172:175], a[104:107], v[136:139], v[172:175]
    ds_read_b128 v[128:131], v74 offset:20480
    s_waitcnt lgkmcnt(5)
    v_mfma_f32_16x16x32_bf16 v[168:171], a[60:63], v[140:143], v[168:171]
    v_mfma_f32_16x16x32_bf16 v[172:175], a[108:111], v[140:143], v[172:175]
    ds_read_b128 v[132:135], v74 offset:21504
    s_waitcnt lgkmcnt(5)
    v_mfma_f32_16x16x32_bf16 v[168:171], a[64:67], v[112:115], v[168:171]
    v_mfma_f32_16x16x32_bf16 v[172:175], a[112:115], v[112:115], v[172:175]
    ds_read_b128 v[136:139], v74 offset:22528
    s_waitcnt lgkmcnt(5)
    v_mfma_f32_16x16x32_bf16 v[168:171], a[68:71], v[116:119], v[168:171]
    v_mfma_f32_16x16x32_bf16 v[172:175], a[116:119], v[116:119], v[172:175]
    ds_read_b128 v[140:143], v74 offset:23552
    s_waitcnt lgkmcnt(5)
    v_mfma_f32_16x16x32_bf16 v[168:171], a[72:75], v[120:123], v[168:171]
    v_mfma_f32_16x16x32_bf16 v[172:175], a[120:123], v[120:123], v[172:175]
    s_waitcnt lgkmcnt(4)
    v_mfma_f32_16x16x32_bf16 v[168:171], a[76:79], v[124:127], v[168:171]
    v_mfma_f32_16x16x32_bf16 v[172:175], a[124:127], v[124:127], v[172:175]
    s_waitcnt lgkmcnt(3)
    v_mfma_f32_16x16x32_bf16 v[168:171], a[80:83], v[128:131], v[168:171]
    v_mfma_f32_16x16x32_bf16 v[172:175], a[128:131], v[128:131], v[172:175]
    s_waitcnt lgkmcnt(2)
    v_mfma_f32_16x16x32_bf16 v[168:171], a[84:87], v[132:135], v[168:171]
    v_mfma_f32_16x16x32_bf16 v[172:175], a[132:135], v[132:135], v[172:175]
    s_waitcnt lgkmcnt(1)
    v_mfma_f32_16x16x32_bf16 v[168:171], a[88:91], v[136:139], v[168:171]
    v_mfma_f32_16x16x32_bf16 v[172:175], a[136:139], v[136:139], v[172:175]
    s_waitcnt lgkmcnt(0)
    v_mfma_f32_16x16x32_bf16 v[168:171], a[92:95], v[140:143], v[168:171]
    v_mfma_f32_16x16x32_bf16 v[172:175], a[140:143], v[140:143], v[172:175]
L_k_chk:
    v_cmp_u_f32 s[56:57], v152, v153
    v_cmp_u_f32 s[16:17], v154, v155
    v_cmp_u_f32 s[14:15], v156, v157
    v_cmp_u_f32 vcc, v158, v159
    s_or_b64 s[56:57], s[56:57], s[16:17]
    s_or_b64 vcc, vcc, s[14:15]
    s_or_b64 s[56:57], vcc, s[56:57]
    v_cmp_u_f32 vcc, v160, v160
    s_or_b64 vcc, vcc, s[56:57]
    s_cbranch_scc1 L_k_redo
L_k_ok:
    v_pk_fma_f32 v[144:145], v[144:145], v[192:193], v[80:81] neg_lo:[0,0,1] neg_hi:[0,0,1]
    v_pk_fma_f32 v[146:147], v[146:147], v[194:195], v[82:83] neg_lo:[0,0,1] neg_hi:[0,0,1]
    v_pk_fma_f32 v[148:149], v[148:149], v[196:197], v[84:85] neg_lo:[0,0,1] neg_hi:[0,0,1]
    v_pk_fma_f32 v[150:151], v[150:151], v[198:199], v[86:87] neg_lo:[0,0,1] neg_hi:[0,0,1]
    v_pk_fma_f32 v[152:153], v[152:153], v[200:201], v[88:89] neg_lo:[0,0,1] neg_hi:[0,0,1]
    v_pk_fma_f32 v[154:155], v[154:155], v[202:203], v[90:91] neg_lo:[0,0,1] neg_hi:[0,0,1]
    v_pk_fma_f32 v[156:157], v[156:157], v[204:205], v[92:93] neg_lo:[0,0,1] neg_hi:[0,0,1]
    v_pk_fma_f32 v[158:159], v[158:159], v[206:207], v[94:95] neg_lo:[0,0,1] neg_hi:[0,0,1]
    v_max3_f32 v184, v144, v145, v146
    v_max3_f32 v184, v184, v147, v148
    v_max3_f32 v184, v184, v149, v150
    v_max3_f32 v184, v184, v151, v152
    v_max3_f32 v184, v184, v153, v154
    v_max3_f32 v184, v184, v155, v156
    v_max3_f32 v184, v184, v157, v158
    v_max_f32 v184, v184, v159
    v_mov_b32 v250, v184
    s_nop 1
    v_permlane16_swap_b32 v184, v250
    s_nop 0
    v_max_f32 v184, v184, v250
    v_mov_b32 v250, v184
    s_nop 1
    v_permlane32_swap_b32 v184, v250
    s_nop 0
    v_max_f32 v184, v184, v250
    v_mov_b32 v248, v184
    v_mov_b32 v249, v184
    v_pk_add_f32 v[144:145], v[144:145], v[248:249] neg_lo:[0,1] neg_hi:[0,1]
    v_pk_add_f32 v[146:147], v[146:147], v[248:249] neg_lo:[0,1] neg_hi:[0,1]
    v_pk_add_f32 v[148:149], v[148:149], v[248:249] neg_lo:[0,1] neg_hi:[0,1]
    v_pk_add_f32 v[150:151], v[150:151], v[248:249] neg_lo:[0,1] neg_hi:[0,1]
    v_pk_add_f32 v[152:153], v[152:153], v[248:249] neg_lo:[0,1] neg_hi:[0,1]
    v_pk_add_f32 v[154:155], v[154:155], v[248:249] neg_lo:[0,1] neg_hi:[0,1]
    v_pk_add_f32 v[156:157], v[156:157], v[248:249] neg_lo:[0,1] neg_hi:[0,1]
    v_pk_add_f32 v[158:159], v[158:159], v[248:249] neg_lo:[0,1] neg_hi:[0,1]
    v_exp_f32 v144, v144
    v_exp_f32 v145, v145
    v_exp_f32 v146, v146
    v_exp_f32 v147, v147
    v_exp_f32 v148, v148
    v_exp_f32 v149, v149
    v_exp_f32 v150, v150
    v_exp_f32 v151, v151
    v_exp_f32 v152, v152
    v_exp_f32 v153, v153
    v_exp_f32 v154, v154
    v_exp_f32 v155, v155
    v_exp_f32 v156, v156
    v_exp_f32 v157, v157
    v_exp_f32 v158, v158
    v_exp_f32 v159, v159
    s_nop 0
    v_cvt_pk_bf16_f32 v16, v144, v145
    v_cvt_pk_bf16_f32 v17, v146, v147
    v_cvt_pk_bf16_f32 v18, v148, v149
    v_cvt_pk_bf16_f32 v19, v150, v151
    v_cvt_pk_bf16_f32 v20, v152, v153
    v_cvt_pk_bf16_f32 v21, v154, v155
    v_cvt_pk_bf16_f32 v22, v156, v157
    v_cvt_pk_bf16_f32 v23, v158, v159
    v_pk_fma_f32 v[160:161], v[160:161], v[192:193], v[96:97] neg_lo:[0,0,1] neg_hi:[0,0,1]
    v_pk_fma_f32 v[162:163], v[162:163], v[194:195], v[98:99] neg_lo:[0,0,1] neg_hi:[0,0,1]
    v_pk_fma_f32 v[164:165], v[164:165], v[196:197], v[100:101] neg_lo:[0,0,1] neg_hi:[0,0,1]
    v_pk_fma_f32 v[166:167], v[166:167], v[198:199], v[102:103] neg_lo:[0,0,1] neg_hi:[0,0,1]
    v_pk_fma_f32 v[168:169], v[168:169], v[200:201], v[104:105] neg_lo:[0,0,1] neg_hi:[0,0,1]
    v_pk_fma_f32 v[170:171], v[170:171], v[202:203], v[106:107] neg_lo:[0,0,1] neg_hi:[0,0,1]
    v_pk_fma_f32 v[172:173], v[172:173], v[204:205], v[108:109] neg_lo:[0,0,1] neg_hi:[0,0,1]
    v_pk_fma_f32 v[174:175], v[174:175], v[206:207], v[110:111] neg_lo:[0,0,1] neg_hi:[0,0,1]
    v_max3_f32 v185, v160, v161, v162
    v_max3_f32 v185, v185, v163, v164
    v_max3_f32 v185, v185, v165, v166
    v_max3_f32 v185, v185, v167, v168
    v_max3_f32 v185, v185, v169, v170
    v_max3_f32 v185, v185, v171, v172
    v_max3_f32 v185, v185, v173, v174
    v_max_f32 v185, v185, v175
    v_mov_b32 v254, v185
    s_nop 1
    v_permlane16_swap_b32 v185, v254
    s_nop 0
    v_max_f32 v185, v185, v254
    v_mov_b32 v254, v185
    s_nop 1
    v_permlane32_swap_b32 v185, v254
    s_nop 0
    v_max_f32 v185, v185, v254
    v_mov_b32 v252, v185
    v_mov_b32 v253, v185
    v_pk_add_f32 v[160:161], v[160:161], v[252:253] neg_lo:[0,1] neg_hi:[0,1]
    v_pk_add_f32 v[162:163], v[162:163], v[252:253] neg_lo:[0,1] neg_hi:[0,1]
    v_pk_add_f32 v[164:165], v[164:165], v[252:253] neg_lo:[0,1] neg_hi:[0,1]
    v_pk_add_f32 v[166:167], v[166:167], v[252:253] neg_lo:[0,1] neg_hi:[0,1]
    v_pk_add_f32 v[168:169], v[168:169], v[252:253] neg_lo:[0,1] neg_hi:[0,1]
    v_pk_add_f32 v[170:171], v[170:171], v[252:253] neg_lo:[0,1] neg_hi:[0,1]
    v_pk_add_f32 v[172:173], v[172:173], v[252:253] neg_lo:[0,1] neg_hi:[0,1]
    v_pk_add_f32 v[174:175], v[174:175], v[252:253] neg_lo:[0,1] neg_hi:[0,1]
    s_waitcnt vmcnt(0)
    s_lshl_b32 s27, s21, 2
    s_add_u32 s27, s27, s22
    s_and_b32 s27, s27, 127
    s_cmp_lg_u32 s27, 3
    s_cbranch_scc1 L_nowb_21
    buffer_wbl2 sc1
L_nowb_21:
    v_mfma_f32_16x16x32_bf16 v[80:83], a[144:147], v[16:19], 0
    v_exp_f32 v160, v160
    v_mfma_f32_16x16x32_bf16 v[84:87], a[148:151], v[16:19], 0
    v_exp_f32 v161, v161
    v_mfma_f32_16x16x32_bf16 v[88:91], a[152:155], v[16:19], 0
    v_exp_f32 v162, v162
    v_mfma_f32_16x16x32_bf16 v[92:95], a[156:159], v[16:19], 0
    v_exp_f32 v163, v163
    v_mfma_f32_16x16x32_bf16 v[96:99], a[160:163], v[16:19], 0
    v_exp_f32 v164, v164
    v_mfma_f32_16x16x32_bf16 v[100:103], a[164:167], v[16:19], 0
    v_exp_f32 v165, v165
    v_mfma_f32_16x16x32_bf16 v[176:179], v[12:15], v[16:19], 0
    v_exp_f32 v166, v166
    v_mfma_f32_16x16x32_bf16 v[80:83], a[168:171], v[20:23], v[80:83]
    v_exp_f32 v167, v167
    v_mfma_f32_16x16x32_bf16 v[84:87], a[172:175], v[20:23], v[84:87]
    v_exp_f32 v168, v168
    v_mfma_f32_16x16x32_bf16 v[88:91], a[176:179], v[20:23], v[88:91]
    v_exp_f32 v169, v169
    v_mfma_f32_16x16x32_bf16 v[92:95], a[180:183], v[20:23], v[92:95]
    v_exp_f32 v170, v170
    v_mfma_f32_16x16x32_bf16 v[96:99], a[184:187], v[20:23], v[96:99]
    v_exp_f32 v171, v171
    v_mfma_f32_16x16x32_bf16 v[100:103], a[188:191], v[20:23], v[100:103]
    v_exp_f32 v172, v172
    v_mfma_f32_16x16x32_bf16 v[176:179], v[12:15], v[20:23], v[176:179]
    v_exp_f32 v173, v173
    v_exp_f32 v174, v174
    v_exp_f32 v175, v175
    s_nop 0
    v_cvt_pk_bf16_f32 v24, v160, v161
    v_cvt_pk_bf16_f32 v25, v162, v163
    v_cvt_pk_bf16_f32 v26, v164, v165
    v_cvt_pk_bf16_f32 v27, v166, v167
    v_cvt_pk_bf16_f32 v28, v168, v169
    v_cvt_pk_bf16_f32 v29, v170, v171
    v_cvt_pk_bf16_f32 v30, v172, v173
    v_cvt_pk_bf16_f32 v31, v174, v175
    v_mov_b32 v8, v184
    v_mov_b32 v9, v176
    v_mfma_f32_16x16x32_bf16 v[104:107], a[144:147], v[24:27], 0
    v_lshlrev_b32 v144, 16, v220
    v_mfma_f32_16x16x32_bf16 v[108:111], a[148:151], v[24:27], 0
    ds_write_b128 v75, v[80:83] offset:0
    v_mfma_f32_16x16x32_bf16 v[112:115], a[152:155], v[24:27], 0
    v_and_b32 v145, 0xffff0000, v220
    v_mfma_f32_16x16x32_bf16 v[116:119], a[156:159], v[24:27], 0
    ds_write_b128 v75, v[84:87] offset:1024
    v_mfma_f32_16x16x32_bf16 v[120:123], a[160:163], v[24:27], 0
    v_lshlrev_b32 v146, 16, v221
    v_mfma_f32_16x16x32_bf16 v[124:127], a[164:167], v[24:27], 0
    ds_write_b128 v75, v[88:91] offset:16384
    v_mfma_f32_16x16x32_bf16 v[180:183], v[12:15], v[24:27], 0
    v_and_b32 v147, 0xffff0000, v221
    v_mfma_f32_16x16x32_bf16 v[104:107], a[168:171], v[28:31], v[104:107]
    ds_write_b128 v75, v[92:95] offset:17408
    v_mfma_f32_16x16x32_bf16 v[108:111], a[172:175], v[28:31], v[108:111]
    v_lshlrev_b32 v148, 16, v222
    v_mfma_f32_16x16x32_bf16 v[112:115], a[176:179], v[28:31], v[112:115]
    ds_write_b128 v75, v[96:99] offset:32768
    v_mfma_f32_16x16x32_bf16 v[116:119], a[180:183], v[28:31], v[116:119]
    v_and_b32 v149, 0xffff0000, v222
    v_mfma_f32_16x16x32_bf16 v[120:123], a[184:187], v[28:31], v[120:123]
    ds_write_b128 v75, v[100:103] offset:33792
    v_mfma_f32_16x16x32_bf16 v[124:127], a[188:191], v[28:31], v[124:127]
    v_lshlrev_b32 v150, 16, v223
    v_mfma_f32_16x16x32_bf16 v[180:183], v[12:15], v[28:31], v[180:183]
    ds_write_b64 v76, v[8:9]
    v_and_b32 v151, 0xffff0000, v223
    v_lshlrev_b32 v152, 16, v224
    v_and_b32 v153, 0xffff0000, v224
    ds_write_b128 v75, v[104:107] offset:8192
    v_lshlrev_b32 v154, 16, v225
    ds_write_b128 v75, v[108:111] offset:9216
    v_and_b32 v155, 0xffff0000, v225
    ds_write_b128 v75, v[112:115] offset:24576
    v_lshlrev_b32 v156, 16, v226
    ds_write_b128 v75, v[116:119] offset:25600
    v_and_b32 v157, 0xffff0000, v226
    ds_write_b128 v75, v[120:123] offset:40960
    v_lshlrev_b32 v158, 16, v227
    ds_write_b128 v75, v[124:127] offset:41984
    v_and_b32 v159, 0xffff0000, v227
    v_mov_b32 v10, v185
    v_mov_b32 v11, v180
    ds_write_b64 v76, v[10:11] offset:128
    s_waitcnt lgkmcnt(0)
    s_barrier
    ds_read_b64 v[160:161], v77 offset:0
    ds_read_b64 v[162:163], v77 offset:256
    ds_read_b64 v[164:165], v77 offset:512
    ds_read_b64 v[166:167], v77 offset:768
    ds_read_b128 v[80:83], v213 offset:0
    ds_read_b128 v[84:87], v213 offset:1024
    ds_read_b128 v[88:91], v213 offset:2048
    ds_read_b128 v[92:95], v213 offset:3072
    ds_read_b128 v[96:99], v213 offset:4096
    ds_read_b128 v[100:103], v213 offset:5120
    ds_read_b128 v[104:107], v213 offset:6144
    ds_read_b128 v[108:111], v213 offset:7168
    s_waitcnt lgkmcnt(8)
    v_max3_f32 v7, v160, v162, v164
    v_max_f32 v7, v7, v166
    v_sub_f32 v168, v160, v7
    v_sub_f32 v170, v162, v7
    v_sub_f32 v172, v164, v7
    v_sub_f32 v174, v166, v7
    v_exp_f32 v168, v168
    v_exp_f32 v170, v170
    v_exp_f32 v172, v172
    v_exp_f32 v174, v174
    s_waitcnt lgkmcnt(2)
    s_cmp_ge_u32 s22, 2
    s_cbranch_scc1 L_nord2
    ds_read_b128 v[112:115], v213 offset:32768
    ds_read_b128 v[116:119], v213 offset:33792
    ds_read_b128 v[120:123], v213 offset:34816
    ds_read_b128 v[124:127], v213 offset:35840
    ds_read_b128 v[128:131], v213 offset:36864
    ds_read_b128 v[132:135], v213 offset:37888
    ds_read_b128 v[136:139], v213 offset:38912
    ds_read_b128 v[140:143], v213 offset:39936
    s_waitcnt lgkmcnt(8)
    s_branch L_rd1
L_nord2:
    s_waitcnt lgkmcnt(0)
L_rd1:
    v_mul_f32 v7, v168, v161
    v_fmac_f32 v7, v170, v163
    v_fmac_f32 v7, v172, v165
    v_fmac_f32 v7, v174, v167
    v_rcp_f32 v7, v7
    s_nop 0
    v_mul_f32 v168, v168, v7
    v_mov_b32 v169, v168
    v_mul_f32 v170, v170, v7
    v_mov_b32 v171, v170
    v_mul_f32 v172, v172, v7
    v_mov_b32 v173, v172
    v_mul_f32 v174, v174, v7
    v_mov_b32 v175, v174
    v_pk_fma_f32 v[144:145], v[80:81], v[168:169], v[144:145]
    v_pk_fma_f32 v[146:147], v[82:83], v[168:169], v[146:147]
    v_pk_fma_f32 v[148:149], v[84:85], v[168:169], v[148:149]
    v_pk_fma_f32 v[150:151], v[86:87], v[168:169], v[150:151]
    v_pk_fma_f32 v[144:145], v[88:89], v[170:171], v[144:145]
    v_pk_fma_f32 v[146:147], v[90:91], v[170:171], v[146:147]
    v_pk_fma_f32 v[148:149], v[92:93], v[170:171], v[148:149]
    v_pk_fma_f32 v[150:151], v[94:95], v[170:171], v[150:151]
    v_pk_fma_f32 v[144:145], v[96:97], v[172:173], v[144:145]
    v_pk_fma_f32 v[146:147], v[98:99], v[172:173], v[146:147]
    v_pk_fma_f32 v[148:149], v[100:101], v[172:173], v[148:149]
    v_pk_fma_f32 v[150:151], v[102:103], v[172:173], v[150:151]
    v_pk_fma_f32 v[144:145], v[104:105], v[174:175], v[144:145]
    v_pk_fma_f32 v[146:147], v[106:107], v[174:175], v[146:147]
    v_pk_fma_f32 v[148:149], v[108:109], v[174:175], v[148:149]
    v_pk_fma_f32 v[150:151], v[110:111], v[174:175], v[150:151]
    v_cvt_pk_bf16_f32 v176, v144, v145
    v_cvt_pk_bf16_f32 v177, v146, v147
    v_cvt_pk_bf16_f32 v178, v148, v149
    v_cvt_pk_bf16_f32 v179, v150, v151
    buffer_store_dwordx4 v[176:179], v70, s[44:47], s6 offen
    s_cmp_ge_u32 s22, 2
    s_cbranch_scc1 L_fin
    s_waitcnt lgkmcnt(6)
    v_pk_fma_f32 v[152:153], v[112:113], v[168:169], v[152:153]
    v_pk_fma_f32 v[154:155], v[114:115], v[168:169], v[154:155]
    v_pk_fma_f32 v[156:157], v[116:117], v[168:169], v[156:157]
    v_pk_fma_f32 v[158:159], v[118:119], v[168:169], v[158:159]
    s_waitcnt lgkmcnt(4)
    v_pk_fma_f32 v[152:153], v[120:121], v[170:171], v[152:153]
    v_pk_fma_f32 v[154:155], v[122:123], v[170:171], v[154:155]
    v_pk_fma_f32 v[156:157], v[124:125], v[170:171], v[156:157]
    v_pk_fma_f32 v[158:159], v[126:127], v[170:171], v[158:159]
    s_waitcnt lgkmcnt(2)
    v_pk_fma_f32 v[152:153], v[128:129], v[172:173], v[152:153]
    v_pk_fma_f32 v[154:155], v[130:131], v[172:173], v[154:155]
    v_pk_fma_f32 v[156:157], v[132:133], v[172:173], v[156:157]
    v_pk_fma_f32 v[158:159], v[134:135], v[172:173], v[158:159]
    s_waitcnt lgkmcnt(0)
    v_pk_fma_f32 v[152:153], v[136:137], v[174:175], v[152:153]
    v_pk_fma_f32 v[154:155], v[138:139], v[174:175], v[154:155]
    v_pk_fma_f32 v[156:157], v[140:141], v[174:175], v[156:157]
    v_pk_fma_f32 v[158:159], v[142:143], v[174:175], v[158:159]
    v_cvt_pk_bf16_f32 v180, v152, v153
    v_cvt_pk_bf16_f32 v181, v154, v155
    v_cvt_pk_bf16_f32 v182, v156, v157
    v_cvt_pk_bf16_f32 v183, v158, v159
    buffer_store_dwordx4 v[180:183], v70, s[44:47], s7 offen offset:128
L_fin:
    s_or_b32 s27, s2, s22
    s_cmp_lg_u32 s27, 0
    s_cbranch_scc1 L_nononce
    s_mov_b64 exec, 1
    buffer_store_dword v229, v228, s[32:35], 0 offen
    s_mov_b64 exec, -1
L_nononce:
L_end:
    s_endpgm
L_p2_redo:
    s_sub_u32 s70, s70, 1
    s_cbranch_scc1 L_p2_give
    s_waitcnt vmcnt(0)
    buffer_load_dwordx4 v[16:19], v71, s[32:35], s76 offen offset:0 sc1
    buffer_load_dwordx4 a[0:3], v71, s[32:35], s77 offen offset:0 sc1
    buffer_load_dwordx4 v[20:23], v71, s[32:35], s76 offen offset:1024 sc1
    buffer_load_dwordx4 a[4:7], v71, s[32:35], s77 offen offset:1024 sc1
    buffer_load_dwordx4 v[24:27], v71, s[32:35], s76 offen offset:2048 sc1
    buffer_load_dwordx4 a[8:11], v71, s[32:35], s77 offen offset:2048 sc1
    buffer_load_dwordx4 v[28:31], v71, s[32:35], s76 offen offset:3072 sc1
    buffer_load_dwordx4 a[12:15], v71, s[32:35], s77 offen offset:3072 sc1
    buffer_load_dwordx4 v[32:35], v79, s[32:35], s76 offen offset:0 sc1
    buffer_load_dwordx4 a[16:19], v79, s[32:35], s77 offen offset:0 sc1
    buffer_load_dwordx4 v[36:39], v79, s[32:35], s76 offen offset:1024 sc1
    buffer_load_dwordx4 a[20:23], v79, s[32:35], s77 offen offset:1024 sc1
    buffer_load_dwordx4 v[40:43], v79, s[32:35], s76 offen offset:2048 sc1
    buffer_load_dwordx4 a[24:27], v79, s[32:35], s77 offen offset:2048 sc1
    buffer_load_dwordx4 v[44:47], v79, s[32:35], s76 offen offset:3072 sc1
    buffer_load_dwordx4 a[28:31], v79, s[32:35], s77 offen offset:3072 sc1
    buffer_load_dwordx4 v[48:51], v78, s[32:35], s76 offen offset:0 sc1
    buffer_load_dwordx4 a[32:35], v78, s[32:35], s77 offen offset:0 sc1
    buffer_load_dwordx4 v[52:55], v78, s[32:35], s76 offen offset:1024 sc1
    buffer_load_dwordx4 a[36:39], v78, s[32:35], s77 offen offset:1024 sc1
    buffer_load_dwordx4 v[56:59], v78, s[32:35], s76 offen offset:2048 sc1
    buffer_load_dwordx4 a[40:43], v78, s[32:35], s77 offen offset:2048 sc1
    buffer_load_dwordx4 v[60:63], v78, s[32:35], s76 offen offset:3072 sc1
    buffer_load_dwordx4 a[44:47], v78, s[32:35], s77 offen offset:3072 sc1
    s_waitcnt vmcnt(0)
    s_bitcmp0_b32 s21, 3
    s_cbranch_scc1 L_p2_go0
    s_branch L_p2_go1
L_p2_give:
    s_mov_b32 s70, 0
    s_bitcmp0_b32 s21, 3
    s_cbranch_scc1 L_p2_q_on
    s_branch L_p2_v_on
L_k_redo:
    s_sub_u32 s70, s70, 1
    s_cbranch_scc1 L_k_ok
    s_waitcnt vmcnt(0)
    buffer_load_dwordx4 a[48:51], v71, s[32:35], s78 offen offset:0 sc1
    buffer_load_dwordx4 a[52:55], v71, s[32:35], s78 offen offset:1024 sc1
    buffer_load_dwordx4 a[56:59], v71, s[32:35], s78 offen offset:2048 sc1
    buffer_load_dwordx4 a[60:63], v71, s[32:35], s78 offen offset:3072 sc1
    buffer_load_dwordx4 a[64:67], v79, s[32:35], s78 offen offset:0 sc1
    buffer_load_dwordx4 a[68:71], v79, s[32:35], s78 offen offset:1024 sc1
    buffer_load_dwordx4 a[72:75], v79, s[32:35], s78 offen offset:2048 sc1
    buffer_load_dwordx4 a[76:79], v79, s[32:35], s78 offen offset:3072 sc1
    buffer_load_dwordx4 a[80:83], v78, s[32:35], s78 offen offset:0 sc1
    buffer_load_dwordx4 a[84:87], v78, s[32:35], s78 offen offset:1024 sc1
    buffer_load_dwordx4 a[88:91], v78, s[32:35], s78 offen offset:2048 sc1
    buffer_load_dwordx4 a[92:95], v78, s[32:35], s78 offen offset:3072 sc1
    buffer_load_dwordx4 a[96:99], v71, s[32:35], s79 offen offset:0 sc1
    buffer_load_dwordx4 a[100:103], v71, s[32:35], s79 offen offset:1024 sc1
    buffer_load_dwordx4 a[104:107], v71, s[32:35], s79 offen offset:2048 sc1
    buffer_load_dwordx4 a[108:111], v71, s[32:35], s79 offen offset:3072 sc1
    buffer_load_dwordx4 a[112:115], v79, s[32:35], s79 offen offset:0 sc1
    buffer_load_dwordx4 a[116:119], v79, s[32:35], s79 offen offset:1024 sc1
    buffer_load_dwordx4 a[120:123], v79, s[32:35], s79 offen offset:2048 sc1
    buffer_load_dwordx4 a[124:127], v79, s[32:35], s79 offen offset:3072 sc1
    buffer_load_dwordx4 a[128:131], v78, s[32:35], s79 offen offset:0 sc1
    buffer_load_dwordx4 a[132:135], v78, s[32:35], s79 offen offset:1024 sc1
    buffer_load_dwordx4 a[136:139], v78, s[32:35], s79 offen offset:2048 sc1
    buffer_load_dwordx4 a[140:143], v78, s[32:35], s79 offen offset:3072 sc1
    s_mul_i32 s30, s22, 3072
    s_sub_u32 s30, s0, s30
    s_mul_i32 s27, s22, 3
    s_sub_u32 s26, s26, s27
    s_mov_b32 s31, 12
L_q_rw:
    s_add_u32 s28, s26, 0
    s_cmp_ge_u32 s28, 12
    s_cselect_b32 s29, 12, 0
    s_sub_u32 s28, s28, s29
    s_mul_i32 s28, s28, 1024
    s_add_u32 m0, s28, 98304
    s_add_u32 s28, s30, 12288
    buffer_load_dwordx4 v68, s[32:35], s30 offen sc1 lds
    s_add_u32 m0, m0, 12288
    s_add_u32 s30, s30, 1024
    buffer_load_dwordx4 v68, s[32:35], s28 offen sc1 lds
    s_add_u32 s26, s26, 1
    s_sub_u32 s31, s31, 1
    s_cmp_lg_u32 s31, 0
    s_cbranch_scc1 L_q_rw
    s_sub_u32 s27, s27, 12
    s_add_u32 s26, s26, s27
    s_waitcnt vmcnt(0)
    ds_read_b128 v[112:115], v74 offset:0
    ds_read_b128 v[116:119], v74 offset:1024
    ds_read_b128 v[120:123], v74 offset:2048
    ds_read_b128 v[124:127], v74 offset:3072
    ds_read_b128 v[128:131], v74 offset:4096
    ds_read_b128 v[132:135], v74 offset:5120
    s_waitcnt lgkmcnt(5)
    v_mfma_f32_16x16x32_bf16 v[144:147], v[16:19], v[112:115], 0
    v_mfma_f32_16x16x32_bf16 v[148:151], a[0:3], v[112:115], 0
    v_mfma_f32_16x16x32_bf16 v[152:155], a[48:51], v[112:115], 0
    v_mfma_f32_16x16x32_bf16 v[156:159], a[96:99], v[112:115], 0
    ds_read_b128 v[136:139], v74 offset:6144
    s_waitcnt lgkmcnt(5)
    v_mfma_f32_16x16x32_bf16 v[144:147], v[20:23], v[116:119], v[144:147]
    v_mfma_f32_16x16x32_bf16 v[148:151], a[4:7], v[116:119], v[148:151]
    v_mfma_f32_16x16x32_bf16 v[152:155], a[52:55], v[116:119], v[152:155]
    v_mfma_f32_16x16x32_bf16 v[156:159], a[100:103], v[116:119], v[156:159]
    ds_read_b128 v[140:143], v74 offset:7168
    s_waitcnt lgkmcnt(5)
    v_mfma_f32_16x16x32_bf16 v[144:147], v[24:27], v[120:123], v[144:147]
    v_mfma_f32_16x16x32_bf16 v[148:151], a[8:11], v[120:123], v[148:151]
    v_mfma_f32_16x16x32_bf16 v[152:155], a[56:59], v[120:123], v[152:155]
    v_mfma_f32_16x16x32_bf16 v[156:159], a[104:107], v[120:123], v[156:159]
    ds_read_b128 v[112:115], v74 offset:8192
    s_waitcnt lgkmcnt(5)
    v_mfma_f32_16x16x32_bf16 v[144:147], v[28:31], v[124:127], v[144:147]
    v_mfma_f32_16x16x32_bf16 v[148:151], a[12:15], v[124:127], v[148:151]
    v_mfma_f32_16x16x32_bf16 v[152:155], a[60:63], v[124:127], v[152:155]
    v_mfma_f32_16x16x32_bf16 v[156:159], a[108:111], v[124:127], v[156:159]
    ds_read_b128 v[116:119], v74 offset:9216
    s_waitcnt lgkmcnt(5)
    v_mfma_f32_16x16x32_bf16 v[144:147], v[32:35], v[128:131], v[144:147]
    v_mfma_f32_16x16x32_bf16 v[148:151], a[16:19], v[128:131], v[148:151]
    v_mfma_f32_16x16x32_bf16 v[152:155], a[64:67], v[128:131], v[152:155]
    v_mfma_f32_16x16x32_bf16 v[156:159], a[112:115], v[128:131], v[156:159]
    ds_read_b128 v[120:123], v74 offset:10240
    s_waitcnt lgkmcnt(5)
    v_mfma_f32_16x16x32_bf16 v[144:147], v[36:39], v[132:135], v[144:147]
    v_mfma_f32_16x16x32_bf16 v[148:151], a[20:23], v[132:135], v[148:151]
    v_mfma_f32_16x16x32_bf16 v[152:155], a[68:71], v[132:135], v[152:155]
    v_mfma_f32_16x16x32_bf16 v[156:159], a[116:119], v[132:135], v[156:159]
    ds_read_b128 v[124:127], v74 offset:11264
    s_waitcnt lgkmcnt(5)
    v_mfma_f32_16x16x32_bf16 v[144:147], v[40:43], v[136:139], v[144:147]
    v_mfma_f32_16x16x32_bf16 v[148:151], a[24:27], v[136:139], v[148:151]
    v_mfma_f32_16x16x32_bf16 v[152:155], a[72:75], v[136:139], v[152:155]
    v_mfma_f32_16x16x32_bf16 v[156:159], a[120:123], v[136:139], v[156:159]
    ds_read_b128 v[128:131], v74 offset:12288
    s_waitcnt lgkmcnt(5)
    v_mfma_f32_16x16x32_bf16 v[144:147], v[44:47], v[140:143], v[144:147]
    v_mfma_f32_16x16x32_bf16 v[148:151], a[28:31], v[140:143], v[148:151]
    v_mfma_f32_16x16x32_bf16 v[152:155], a[76:79], v[140:143], v[152:155]
    v_mfma_f32_16x16x32_bf16 v[156:159], a[124:127], v[140:143], v[156:159]
    ds_read_b128 v[132:135], v74 offset:13312
    s_waitcnt lgkmcnt(5)
    v_mfma_f32_16x16x32_bf16 v[144:147], v[48:51], v[112:115], v[144:147]
    v_mfma_f32_16x16x32_bf16 v[148:151], a[32:35], v[112:115], v[148:151]
    v_mfma_f32_16x16x32_bf16 v[152:155], a[80:83], v[112:115], v[152:155]
    v_mfma_f32_16x16x32_bf16 v[156:159], a[128:131], v[112:115], v[156:159]
    ds_read_b128 v[136:139], v74 offset:14336
    s_waitcnt lgkmcnt(5)
    v_mfma_f32_16x16x32_bf16 v[144:147], v[52:55], v[116:119], v[144:147]
    v_mfma_f32_16x16x32_bf16 v[148:151], a[36:39], v[116:119], v[148:151]
    v_mfma_f32_16x16x32_bf16 v[152:155], a[84:87], v[116:119], v[152:155]
    v_mfma_f32_16x16x32_bf16 v[156:159], a[132:135], v[116:119], v[156:159]
    ds_read_b128 v[140:143], v74 offset:15360
    s_waitcnt lgkmcnt(5)
    v_mfma_f32_16x16x32_bf16 v[144:147], v[56:59], v[120:123], v[144:147]
    v_mfma_f32_16x16x32_bf16 v[148:151], a[40:43], v[120:123], v[148:151]
    v_mfma_f32_16x16x32_bf16 v[152:155], a[88:91], v[120:123], v[152:155]
    v_mfma_f32_16x16x32_bf16 v[156:159], a[136:139], v[120:123], v[156:159]
    ds_read_b128 v[112:115], v74 offset:16384
    s_waitcnt lgkmcnt(5)
    v_mfma_f32_16x16x32_bf16 v[144:147], v[60:63], v[124:127], v[144:147]
    v_mfma_f32_16x16x32_bf16 v[148:151], a[44:47], v[124:127], v[148:151]
    v_mfma_f32_16x16x32_bf16 v[152:155], a[92:95], v[124:127], v[152:155]
    v_mfma_f32_16x16x32_bf16 v[156:159], a[140:143], v[124:127], v[156:159]
    ds_read_b128 v[116:119], v74 offset:17408
    s_waitcnt lgkmcnt(5)
    v_mfma_f32_16x16x32_bf16 v[160:163], v[16:19], v[128:131], 0
    v_mfma_f32_16x16x32_bf16 v[164:167], a[0:3], v[128:131], 0
    v_mfma_f32_16x16x32_bf16 v[168:171], a[48:51], v[128:131], 0
    v_mfma_f32_16x16x32_bf16 v[172:175], a[96:99], v[128:131], 0
    ds_read_b128 v[120:123], v74 offset:18432
    s_waitcnt lgkmcnt(5)
    v_mfma_f32_16x16x32_bf16 v[160:163], v[20:23], v[132:135], v[160:163]
    v_mfma_f32_16x16x32_bf16 v[164:167], a[4:7], v[132:135], v[164:167]
    v_mfma_f32_16x16x32_bf16 v[168:171], a[52:55], v[132:135], v[168:171]
    v_mfma_f32_16x16x32_bf16 v[172:175], a[100:103], v[132:135], v[172:175]
    ds_read_b128 v[124:127], v74 offset:19456
    s_waitcnt lgkmcnt(5)
    v_mfma_f32_16x16x32_bf16 v[160:163], v[24:27], v[136:139], v[160:163]
    v_mfma_f32_16x16x32_bf16 v[164:167], a[8:11], v[136:139], v[164:167]
    v_mfma_f32_16x16x32_bf16 v[168:171], a[56:59], v[136:139], v[168:171]
    v_mfma_f32_16x16x32_bf16 v[172:175], a[104:107], v[136:139], v[172:175]
    ds_read_b128 v[128:131], v74 offset:20480
    s_waitcnt lgkmcnt(5)
    v_mfma_f32_16x16x32_bf16 v[160:163], v[28:31], v[140:143], v[160:163]
    v_mfma_f32_16x16x32_bf16 v[164:167], a[12:15], v[140:143], v[164:167]
    v_mfma_f32_16x16x32_bf16 v[168:171], a[60:63], v[140:143], v[168:171]
    v_mfma_f32_16x16x32_bf16 v[172:175], a[108:111], v[140:143], v[172:175]
    ds_read_b128 v[132:135], v74 offset:21504
    s_waitcnt lgkmcnt(5)
    v_mfma_f32_16x16x32_bf16 v[160:163], v[32:35], v[112:115], v[160:163]
    v_mfma_f32_16x16x32_bf16 v[164:167], a[16:19], v[112:115], v[164:167]
    v_mfma_f32_16x16x32_bf16 v[168:171], a[64:67], v[112:115], v[168:171]
    v_mfma_f32_16x16x32_bf16 v[172:175], a[112:115], v[112:115], v[172:175]
    ds_read_b128 v[136:139], v74 offset:22528
    s_waitcnt lgkmcnt(5)
    v_mfma_f32_16x16x32_bf16 v[160:163], v[36:39], v[116:119], v[160:163]
    v_mfma_f32_16x16x32_bf16 v[164:167], a[20:23], v[116:119], v[164:167]
    v_mfma_f32_16x16x32_bf16 v[168:171], a[68:71], v[116:119], v[168:171]
    v_mfma_f32_16x16x32_bf16 v[172:175], a[116:119], v[116:119], v[172:175]
    ds_read_b128 v[140:143], v74 offset:23552
    s_waitcnt lgkmcnt(5)
    v_mfma_f32_16x16x32_bf16 v[160:163], v[40:43], v[120:123], v[160:163]
    v_mfma_f32_16x16x32_bf16 v[164:167], a[24:27], v[120:123], v[164:167]
    v_mfma_f32_16x16x32_bf16 v[168:171], a[72:75], v[120:123], v[168:171]
    v_mfma_f32_16x16x32_bf16 v[172:175], a[120:123], v[120:123], v[172:175]
    s_waitcnt lgkmcnt(4)
    v_mfma_f32_16x16x32_bf16 v[160:163], v[44:47], v[124:127], v[160:163]
    v_mfma_f32_16x16x32_bf16 v[164:167], a[28:31], v[124:127], v[164:167]
    v_mfma_f32_16x16x32_bf16 v[168:171], a[76:79], v[124:127], v[168:171]
    v_mfma_f32_16x16x32_bf16 v[172:175], a[124:127], v[124:127], v[172:175]
    s_waitcnt lgkmcnt(3)
    v_mfma_f32_16x16x32_bf16 v[160:163], v[48:51], v[128:131], v[160:163]
    v_mfma_f32_16x16x32_bf16 v[164:167], a[32:35], v[128:131], v[164:167]
    v_mfma_f32_16x16x32_bf16 v[168:171], a[80:83], v[128:131], v[168:171]
    v_mfma_f32_16x16x32_bf16 v[172:175], a[128:131], v[128:131], v[172:175]
    s_waitcnt lgkmcnt(2)
    v_mfma_f32_16x16x32_bf16 v[160:163], v[52:55], v[132:135], v[160:163]
    v_mfma_f32_16x16x32_bf16 v[164:167], a[36:39], v[132:135], v[164:167]
    v_mfma_f32_16x16x32_bf16 v[168:171], a[84:87], v[132:135], v[168:171]
    v_mfma_f32_16x16x32_bf16 v[172:175], a[132:135], v[132:135], v[172:175]
    s_waitcnt lgkmcnt(1)
    v_mfma_f32_16x16x32_bf16 v[160:163], v[56:59], v[136:139], v[160:163]
    v_mfma_f32_16x16x32_bf16 v[164:167], a[40:43], v[136:139], v[164:167]
    v_mfma_f32_16x16x32_bf16 v[168:171], a[88:91], v[136:139], v[168:171]
    v_mfma_f32_16x16x32_bf16 v[172:175], a[136:139], v[136:139], v[172:175]
    s_waitcnt lgkmcnt(0)
    v_mfma_f32_16x16x32_bf16 v[160:163], v[60:63], v[140:143], v[160:163]
    v_mfma_f32_16x16x32_bf16 v[164:167], a[44:47], v[140:143], v[164:167]
    v_mfma_f32_16x16x32_bf16 v[168:171], a[92:95], v[140:143], v[168:171]
    v_mfma_f32_16x16x32_bf16 v[172:175], a[140:143], v[140:143], v[172:175]
    s_nop 7
    s_branch L_k_chk
L_prod_body:
    s_mov_b32 s32, s18
    s_mov_b32 s33, s19
    s_mov_b32 s44, s14
    s_mov_b32 s45, s15
    s_mov_b32 s46, 1572864
    s_mov_b32 s47, 0x20000
    s_mov_b32 s58, 0x3f803f80
    s_getreg_b32 s24, hwreg(HW_REG_XCC_ID, 0, 3)
    v_mov_b32 v12, s58
    v_mov_b32 v13, s58
    v_mov_b32 v14, s58
    v_mov_b32 v15, s58
    v_mov_b32 v69, 0xffffff00
    v_mov_b32 v228, 0
    v_cmp_eq_u32 s[50:51], 0, v3
    v_lshrrev_b32 v4, 1, v3
    v_lshrrev_b32 v5, 3, v2
    v_cmp_eq_u32 s[48:49], v4, v5
    v_lshrrev_b32 v5, 2, v2
    v_cmp_eq_u32 s[100:101], v3, v5
    s_lshl_b32 s27, s20, 7
    s_add_u32 s27, s27, 4096
    v_and_b32 v5, 31, v1
    v_lshlrev_b32 v5, 10, v5
    v_add_u32 v230, s27, v5
    v_min_u32 v231, 11, v1
    s_mul_i32 s28, s20, 12288
    v_lshlrev_b32 v231, 7, v231
    s_bitcmp0_b32 s21, 3
    s_cselect_b32 s27, 0, 1536
    s_add_u32 s27, s27, 6390272
    s_add_u32 s27, s27, s28
    v_add_u32 v231, s27, v231
    v_min_u32 v4, 5, v1
    v_mul_u32_u24 v4, 768, v4
    s_lshl_b32 s27, s60, 7
    s_add_u32 s27, s27, s28
    s_add_u32 s27, s27, 6385664
    v_add_u32 v246, s27, v4
    v_lshrrev_b32 v4, 2, v2
    v_and_b32 v4, 1, v4
    v_lshlrev_b32 v4, 10, v4
    v_lshrrev_b32 v5, 1, v3
    v_lshl_add_u32 v4, v5, 8, v4
    v_and_b32 v5, 1, v3
    v_lshl_add_u32 v4, v5, 7, v4
    v_lshrrev_b32 v5, 3, v2
    v_lshl_add_u32 v4, v5, 6, v4
    v_and_b32 v5, 3, v2
    v_lshl_add_u32 v9, v5, 4, v4
    s_and_b32 s28, s22, 1
    s_lshl_b32 s28, s28, 9
    v_add_u32 v9, s28, v9
    s_lshl_b32 s25, s64, 7
    s_add_u32 s25, s25, 6385664
    s_lshr_b32 s27, s22, 1
    s_lshl_b32 s28, s66, 1
    s_add_u32 s30, s27, s28
    v_lshrrev_b32 v4, 1, v2
    v_xor_b32 v4, v4, v3
    v_lshlrev_b32 v4, 4, v4
    v_lshl_add_u32 v7, v2, 7, v4
    s_add_u32 s27, s68, 49152
    v_add_u32 v70, s27, v7
    v_xor_b32 v71, 64, v70
    v_add_u32 v72, 49152, v70
    v_add_u32 v73, 49152, v71
    s_mul_i32 s28, s67, 49152
    s_lshl_b32 s27, s30, 12
    s_add_u32 s27, s27, s28
    s_add_u32 s16, s27, 733184
    s_add_u32 s17, s16, 2048
    v_lshlrev_b32 v4, 10, v3
    v_lshrrev_b32 v6, 2, v2
    v_lshl_add_u32 v4, v6, 7, v4
    v_and_b32 v5, 1, v3
    v_lshrrev_b32 v6, 3, v2
    v_lshl_or_b32 v6, v5, 1, v6
    v_lshl_add_u32 v4, v6, 5, v4
    v_and_b32 v6, 3, v2
    v_lshl_add_u32 v74, v6, 3, v4
    v_xor_b32 v75, 32, v74
    v_xor_b32 v76, 64, v74
    v_xor_b32 v77, 96, v74
    s_waitcnt lgkmcnt(0)
    s_and_b32 s27, s23, 0x78787878
    s_add_u32 s27, s27, 0x08080808
    s_and_b32 s28, s23, 0x80808080
    s_xor_b32 s23, s27, s28
    s_or_b32 s24, s24, s23
    s_lshl_b32 s27, s2, 7
    s_add_u32 s27, s27, 4096
    v_mov_b32 v4, s24
    v_mov_b32 v229, s23
    s_mov_b64 exec, 1
    buffer_store_dword v4, v228, s[32:35], s27 offen sc1
    s_mov_b64 exec, -1
    s_and_b32 s52, s23, 0xff
    s_bfe_u32 s53, s23, 0x80008
    s_bfe_u32 s54, s23, 0x80010
    s_lshr_b32 s55, s23, 24
    v_mul_u32_u24 v4, 12288, v1
    s_mov_b64 exec, 0xff
    buffer_load_dword v254, v4, s[32:35], s25 offen sc1
    s_mov_b64 exec, -1
    s_add_u32 m0, s68, 24576
    s_add_u32 s27, s63, 384
    buffer_load_dwordx4 v200, s[40:43], s61 offen lds
    buffer_load_dwordx4 v201, s[40:43], s61 offen offset:1024 lds
    s_add_u32 m0, s68, 73728
    s_add_u32 s61, s61, s26
    buffer_load_dwordx4 v206, s[36:39], s27 offen lds
    buffer_load_dwordx4 v207, s[36:39], s27 offen offset:1024 lds
    s_add_u32 m0, s68, 32768
    s_add_u32 s27, s63, 512
    buffer_load_dwordx4 v200, s[40:43], s61 offen lds
    buffer_load_dwordx4 v201, s[40:43], s61 offen offset:1024 lds
    s_add_u32 m0, s68, 81920
    s_add_u32 s61, s61, s26
    buffer_load_dwordx4 v206, s[36:39], s27 offen lds
    buffer_load_dwordx4 v207, s[36:39], s27 offen offset:1024 lds
    s_add_u32 m0, s68, 40960
    s_add_u32 s27, s63, 640
    buffer_load_dwordx4 v200, s[40:43], s61 offen lds
    buffer_load_dwordx4 v201, s[40:43], s61 offen offset:1024 lds
    s_add_u32 m0, s68, 90112
    s_add_u32 s61, s61, s26
    buffer_load_dwordx4 v206, s[36:39], s27 offen lds
    buffer_load_dwordx4 v207, s[36:39], s27 offen offset:1024 lds
    s_waitcnt vmcnt(22)
    s_barrier
    ds_read_b64_tr_b16 v[80:81], v74 offset:0
    ds_read_b64_tr_b16 v[82:83], v74 offset:512
    ds_read_b128 v[16:19], v70 offset:0
    ds_read_b64_tr_b16 v[84:85], v75 offset:0
    ds_read_b64_tr_b16 v[86:87], v75 offset:512
    ds_read_b64_tr_b16 v[88:89], v76 offset:0
    ds_read_b64_tr_b16 v[90:91], v76 offset:512
    ds_read_b64_tr_b16 v[92:93], v77 offset:0
    ds_read_b64_tr_b16 v[94:95], v77 offset:512
    ds_read_b64_tr_b16 v[96:97], v74 offset:4096
    ds_read_b64_tr_b16 v[98:99], v74 offset:4608
    ds_read_b128 v[28:31], v71 offset:0
    ds_read_b64_tr_b16 v[100:101], v75 offset:4096
    ds_read_b64_tr_b16 v[102:103], v75 offset:4608
    s_waitcnt lgkmcnt(11)
    v_mfma_f32_16x16x32_bf16 v[144:147], v[16:19], v[80:83], 0
    ds_read_b64_tr_b16 v[104:105], v76 offset:4096
    ds_read_b64_tr_b16 v[106:107], v76 offset:4608
    s_waitcnt lgkmcnt(11)
    v_mfma_f32_16x16x32_bf16 v[148:151], v[16:19], v[84:87], 0
    ds_read_b64_tr_b16 v[108:109], v77 offset:4096
    ds_read_b64_tr_b16 v[110:111], v77 offset:4608
    s_waitcnt lgkmcnt(11)
    v_mfma_f32_16x16x32_bf16 v[152:155], v[16:19], v[88:91], 0
    s_waitcnt vmcnt(18)
    s_barrier
    ds_read_b64_tr_b16 v[112:113], v74 offset:8192
    ds_read_b64_tr_b16 v[114:115], v74 offset:8704
    ds_read_b128 v[40:43], v70 offset:8192
    s_waitcnt lgkmcnt(12)
    v_mfma_f32_16x16x32_bf16 v[156:159], v[16:19], v[92:95], 0
    ds_read_b64_tr_b16 v[116:117], v75 offset:8192
    ds_read_b64_tr_b16 v[118:119], v75 offset:8704
    s_waitcnt lgkmcnt(11)
    v_mfma_f32_16x16x32_bf16 v[144:147], v[28:31], v[96:99], v[144:147]
    ds_read_b64_tr_b16 v[120:121], v76 offset:8192
    ds_read_b64_tr_b16 v[122:123], v76 offset:8704
    s_waitcnt lgkmcnt(11)
    v_mfma_f32_16x16x32_bf16 v[148:151], v[28:31], v[100:103], v[148:151]
    ds_read_b64_tr_b16 v[124:125], v77 offset:8192
    ds_read_b64_tr_b16 v[126:127], v77 offset:8704
    s_waitcnt lgkmcnt(11)
    v_mfma_f32_16x16x32_bf16 v[152:155], v[28:31], v[104:107], v[152:155]
    ds_read_b64_tr_b16 v[128:129], v74 offset:12288
    ds_read_b64_tr_b16 v[130:131], v74 offset:12800
    ds_read_b128 v[52:55], v71 offset:8192
    s_waitcnt lgkmcnt(12)
    v_mfma_f32_16x16x32_bf16 v[156:159], v[28:31], v[108:111], v[156:159]
    ds_read_b64_tr_b16 v[132:133], v75 offset:12288
    ds_read_b64_tr_b16 v[134:135], v75 offset:12800
    s_waitcnt lgkmcnt(11)
    v_mfma_f32_16x16x32_bf16 v[144:147], v[40:43], v[112:115], v[144:147]
    ds_read_b64_tr_b16 v[136:137], v76 offset:12288
    ds_read_b64_tr_b16 v[138:139], v76 offset:12800
    s_waitcnt lgkmcnt(11)
    v_mfma_f32_16x16x32_bf16 v[148:151], v[40:43], v[116:119], v[148:151]
    ds_read_b64_tr_b16 v[140:141], v77 offset:12288
    ds_read_b64_tr_b16 v[142:143], v77 offset:12800
    s_waitcnt lgkmcnt(11)
    v_mfma_f32_16x16x32_bf16 v[152:155], v[40:43], v[120:123], v[152:155]
    s_waitcnt vmcnt(14)
    s_barrier
    ds_read_b64_tr_b16 v[80:81], v74 offset:16384
    ds_read_b64_tr_b16 v[82:83], v74 offset:16896
    ds_read_b128 v[16:19], v70 offset:16384
    s_waitcnt lgkmcnt(12)
    v_mfma_f32_16x16x32_bf16 v[156:159], v[40:43], v[124:127], v[156:159]
    ds_read_b64_tr_b16 v[84:85], v75 offset:16384
    ds_read_b64_tr_b16 v[86:87], v75 offset:16896
    s_waitcnt lgkmcnt(11)
    v_mfma_f32_16x16x32_bf16 v[144:147], v[52:55], v[128:131], v[144:147]
    ds_read_b64_tr_b16 v[88:89], v76 offset:16384
    ds_read_b64_tr_b16 v[90:91], v76 offset:16896
    s_waitcnt lgkmcnt(11)
    v_mfma_f32_16x16x32_bf16 v[148:151], v[52:55], v[132:135], v[148:151]
    ds_read_b64_tr_b16 v[92:93], v77 offset:16384
    ds_read_b64_tr_b16 v[94:95], v77 offset:16896
    s_waitcnt lgkmcnt(11)
    v_mfma_f32_16x16x32_bf16 v[152:155], v[52:55], v[136:139], v[152:155]
    ds_read_b64_tr_b16 v[96:97], v74 offset:20480
    ds_read_b64_tr_b16 v[98:99], v74 offset:20992
    ds_read_b128 v[28:31], v71 offset:16384
    s_waitcnt lgkmcnt(12)
    v_mfma_f32_16x16x32_bf16 v[156:159], v[52:55], v[140:143], v[156:159]
    ds_read_b64_tr_b16 v[100:101], v75 offset:20480
    ds_read_b64_tr_b16 v[102:103], v75 offset:20992
    s_waitcnt lgkmcnt(11)
    v_mfma_f32_16x16x32_bf16 v[144:147], v[16:19], v[80:83], v[144:147]
    ds_read_b64_tr_b16 v[104:105], v76 offset:20480
    ds_read_b64_tr_b16 v[106:107], v76 offset:20992
    s_waitcnt lgkmcnt(11)
    v_mfma_f32_16x16x32_bf16 v[148:151], v[16:19], v[84:87], v[148:151]
    ds_read_b64_tr_b16 v[108:109], v77 offset:20480
    ds_read_b64_tr_b16 v[110:111], v77 offset:20992
    s_waitcnt lgkmcnt(11)
    v_mfma_f32_16x16x32_bf16 v[152:155], v[16:19], v[88:91], v[152:155]
    s_waitcnt vmcnt(8)
    s_barrier
    ds_read_b64_tr_b16 v[112:113], v74 offset:24576
    ds_read_b64_tr_b16 v[114:115], v74 offset:25088
    ds_read_b128 v[40:43], v70 offset:24576
    s_waitcnt lgkmcnt(12)
    v_mfma_f32_16x16x32_bf16 v[156:159], v[16:19], v[92:95], v[156:159]
    ds_read_b64_tr_b16 v[116:117], v75 offset:24576
    ds_read_b64_tr_b16 v[118:119], v75 offset:25088
    s_waitcnt lgkmcnt(11)
    v_mfma_f32_16x16x32_bf16 v[144:147], v[28:31], v[96:99], v[144:147]
    ds_read_b64_tr_b16 v[120:121], v76 offset:24576
    ds_read_b64_tr_b16 v[122:123], v76 offset:25088
    s_waitcnt lgkmcnt(11)
    v_mfma_f32_16x16x32_bf16 v[148:151], v[28:31], v[100:103], v[148:151]
    ds_read_b64_tr_b16 v[124:125], v77 offset:24576
    ds_read_b64_tr_b16 v[126:127], v77 offset:25088
    s_waitcnt lgkmcnt(11)
    v_mfma_f32_16x16x32_bf16 v[152:155], v[28:31], v[104:107], v[152:155]
    ds_read_b64_tr_b16 v[128:129], v74 offset:28672
    ds_read_b64_tr_b16 v[130:131], v74 offset:29184
    ds_read_b128 v[52:55], v71 offset:24576
    s_waitcnt lgkmcnt(12)
    v_mfma_f32_16x16x32_bf16 v[156:159], v[28:31], v[108:111], v[156:159]
    ds_read_b64_tr_b16 v[132:133], v75 offset:28672
    ds_read_b64_tr_b16 v[134:135], v75 offset:29184
    s_waitcnt lgkmcnt(11)
    v_mfma_f32_16x16x32_bf16 v[144:147], v[40:43], v[112:115], v[144:147]
    ds_read_b64_tr_b16 v[136:137], v76 offset:28672
    ds_read_b64_tr_b16 v[138:139], v76 offset:29184
    s_waitcnt lgkmcnt(11)
    v_mfma_f32_16x16x32_bf16 v[148:151], v[40:43], v[116:119], v[148:151]
    ds_read_b64_tr_b16 v[140:141], v77 offset:28672
    ds_read_b64_tr_b16 v[142:143], v77 offset:29184
    s_waitcnt lgkmcnt(11)
    v_mfma_f32_16x16x32_bf16 v[152:155], v[40:43], v[120:123], v[152:155]
    s_waitcnt vmcnt(4)
    s_barrier
    ds_read_b64_tr_b16 v[80:81], v74 offset:32768
    ds_read_b64_tr_b16 v[82:83], v74 offset:33280
    ds_read_b128 v[16:19], v70 offset:32768
    s_waitcnt lgkmcnt(12)
    v_mfma_f32_16x16x32_bf16 v[156:159], v[40:43], v[124:127], v[156:159]
    ds_read_b64_tr_b16 v[84:85], v75 offset:32768
    ds_read_b64_tr_b16 v[86:87], v75 offset:33280
    s_waitcnt lgkmcnt(11)
    v_mfma_f32_16x16x32_bf16 v[144:147], v[52:55], v[128:131], v[144:147]
    ds_read_b64_tr_b16 v[88:89], v76 offset:32768
    ds_read_b64_tr_b16 v[90:91], v76 offset:33280
    s_waitcnt lgkmcnt(11)
    v_mfma_f32_16x16x32_bf16 v[148:151], v[52:55], v[132:135], v[148:151]
    ds_read_b64_tr_b16 v[92:93], v77 offset:32768
    ds_read_b64_tr_b16 v[94:95], v77 offset:33280
    s_waitcnt lgkmcnt(11)
    v_mfma_f32_16x16x32_bf16 v[152:155], v[52:55], v[136:139], v[152:155]
    ds_read_b64_tr_b16 v[96:97], v74 offset:36864
    ds_read_b64_tr_b16 v[98:99], v74 offset:37376
    ds_read_b128 v[28:31], v71 offset:32768
    s_waitcnt lgkmcnt(12)
    v_mfma_f32_16x16x32_bf16 v[156:159], v[52:55], v[140:143], v[156:159]
    ds_read_b64_tr_b16 v[100:101], v75 offset:36864
    ds_read_b64_tr_b16 v[102:103], v75 offset:37376
    s_waitcnt lgkmcnt(11)
    v_mfma_f32_16x16x32_bf16 v[144:147], v[16:19], v[80:83], v[144:147]
    ds_read_b64_tr_b16 v[104:105], v76 offset:36864
    ds_read_b64_tr_b16 v[106:107], v76 offset:37376
    s_waitcnt lgkmcnt(11)
    v_mfma_f32_16x16x32_bf16 v[148:151], v[16:19], v[84:87], v[148:151]
    ds_read_b64_tr_b16 v[108:109], v77 offset:36864
    ds_read_b64_tr_b16 v[110:111], v77 offset:37376
    s_waitcnt lgkmcnt(11)
    v_mfma_f32_16x16x32_bf16 v[152:155], v[16:19], v[88:91], v[152:155]
    s_waitcnt vmcnt(0)
    s_barrier
    ds_read_b64_tr_b16 v[112:113], v74 offset:40960
    ds_read_b64_tr_b16 v[114:115], v74 offset:41472
    ds_read_b128 v[40:43], v70 offset:40960
    s_waitcnt lgkmcnt(12)
    v_mfma_f32_16x16x32_bf16 v[156:159], v[16:19], v[92:95], v[156:159]
    ds_read_b64_tr_b16 v[116:117], v75 offset:40960
    ds_read_b64_tr_b16 v[118:119], v75 offset:41472
    s_waitcnt lgkmcnt(11)
    v_mfma_f32_16x16x32_bf16 v[144:147], v[28:31], v[96:99], v[144:147]
    ds_read_b64_tr_b16 v[120:121], v76 offset:40960
    ds_read_b64_tr_b16 v[122:123], v76 offset:41472
    s_waitcnt lgkmcnt(11)
    v_mfma_f32_16x16x32_bf16 v[148:151], v[28:31], v[100:103], v[148:151]
    ds_read_b64_tr_b16 v[124:125], v77 offset:40960
    ds_read_b64_tr_b16 v[126:127], v77 offset:41472
    s_waitcnt lgkmcnt(11)
    v_mfma_f32_16x16x32_bf16 v[152:155], v[28:31], v[104:107], v[152:155]
    ds_read_b64_tr_b16 v[128:129], v74 offset:45056
    ds_read_b64_tr_b16 v[130:131], v74 offset:45568
    ds_read_b128 v[52:55], v71 offset:40960
    s_waitcnt lgkmcnt(12)
    v_mfma_f32_16x16x32_bf16 v[156:159], v[28:31], v[108:111], v[156:159]
    ds_read_b64_tr_b16 v[132:133], v75 offset:45056
    ds_read_b64_tr_b16 v[134:135], v75 offset:45568
    s_waitcnt lgkmcnt(11)
    v_mfma_f32_16x16x32_bf16 v[144:147], v[40:43], v[112:115], v[144:147]
    ds_read_b64_tr_b16 v[136:137], v76 offset:45056
    ds_read_b64_tr_b16 v[138:139], v76 offset:45568
    s_waitcnt lgkmcnt(11)
    v_mfma_f32_16x16x32_bf16 v[148:151], v[40:43], v[116:119], v[148:151]
    ds_read_b64_tr_b16 v[140:141], v77 offset:45056
    ds_read_b64_tr_b16 v[142:143], v77 offset:45568
    s_waitcnt lgkmcnt(11)
    v_mfma_f32_16x16x32_bf16 v[152:155], v[40:43], v[120:123], v[152:155]
    s_waitcnt lgkmcnt(9)
    v_mfma_f32_16x16x32_bf16 v[156:159], v[40:43], v[124:127], v[156:159]
    s_waitcnt lgkmcnt(6)
    v_mfma_f32_16x16x32_bf16 v[144:147], v[52:55], v[128:131], v[144:147]
    s_waitcnt lgkmcnt(4)
    v_mfma_f32_16x16x32_bf16 v[148:151], v[52:55], v[132:135], v[148:151]
    s_waitcnt lgkmcnt(2)
    v_mfma_f32_16x16x32_bf16 v[152:155], v[52:55], v[136:139], v[152:155]
    s_waitcnt lgkmcnt(0)
    v_mfma_f32_16x16x32_bf16 v[156:159], v[52:55], v[140:143], v[156:159]
    s_nop 4
    v_cvt_pk_bf16_f32 v80, v144, v145
    v_cvt_pk_bf16_f32 v81, v146, v147
    v_cvt_pk_bf16_f32 v82, v148, v149
    v_cvt_pk_bf16_f32 v83, v150, v151
    v_cvt_pk_bf16_f32 v84, v152, v153
    v_cvt_pk_bf16_f32 v85, v154, v155
    v_cvt_pk_bf16_f32 v86, v156, v157
    v_cvt_pk_bf16_f32 v87, v158, v159
    v_permlane16_swap_b32 v80, v82
    v_permlane16_swap_b32 v81, v83
    v_permlane16_swap_b32 v84, v86
    v_permlane16_swap_b32 v85, v87
    buffer_store_dwordx4 v[80:83], v9, s[32:35], s16 offen sc1
    buffer_store_dwordx4 v[84:87], v9, s[32:35], s17 offen sc1
L_prod_fin:
    s_waitcnt vmcnt(0)
    s_barrier
    s_cmp_lg_u32 s22, 0
    s_cbranch_scc1 L_nofl_22
    v_mul_u32_u24 v4, 12288, v1
    s_mov_b64 exec, 0xff
    buffer_store_dword v229, v4, s[32:35], s25 offen sc1
    s_mov_b64 exec, -1
L_nofl_22:
    s_cmp_ge_u32 s64, 36
    s_cbranch_scc1 L_prod_out
L_prod_help:
    s_lshl_b32 s27, s59, 1
    s_add_u32 s27, s27, s60
    s_sub_u32 s27, s27, 9
    s_lshl_b32 s27, s27, 2
    s_add_u32 s27, s27, s22
    s_mul_i32 s28, s27, 77
    v_add_u32 v4, s28, v1
    v_min_u32 v4, 1535, v4
    v_lshlrev_b32 v4, 7, v4
    s_mul_i32 s29, s20, 196608
    s_add_u32 s29, s29, 3190784
    s_add_u32 s30, s29, 1572864
    buffer_load_dword v254, v4, s[32:35], s29 offen sc1
    buffer_load_dword v254, v4, s[32:35], s30 offen sc1
    s_add_u32 s28, s28, 64
    v_add_u32 v4, s28, v2
    v_min_u32 v4, 1535, v4
    v_lshlrev_b32 v4, 7, v4
    v_and_b32 v5, 1, v3
    v_mul_u32_u24 v5, 1572864, v5
    v_add3_u32 v4, v4, v5, s29
    s_lshl_b32 s28, s27, 2
    v_and_b32 v5, 3, v1
    v_add_u32 v5, s28, v5
    v_min_u32 v6, 63, v5
    v_lshlrev_b32 v6, 7, v6
    s_lshl_b32 s28, s20, 13
    s_add_u32 s28, s28, 6483968
    v_add_u32 v6, s28, v6
    v_and_b32 v5, 31, v5
    v_lshlrev_b32 v5, 10, v5
    s_lshl_b32 s28, s20, 7
    s_add_u32 s28, s28, 77824
    v_add_u32 v5, s28, v5
    v_cmp_eq_u32 vcc, 2, v3
    s_nop 1
    v_cndmask_b32 v4, v4, v6, vcc
    v_cmp_eq_u32 vcc, 3, v3
    s_nop 1
    v_cndmask_b32 v4, v4, v5, vcc
    buffer_load_dword v254, v4, s[32:35], 0 offen sc1
    s_lshr_b32 s74, s21, 4
    s_lshl_b32 s74, s74, 1
    s_and_b32 s28, s21, 15
    s_mul_i32 s29, s28, 43
    s_lshr_b32 s29, s29, 7
    s_mul_i32 s29, s29, 3
    s_sub_u32 s26, s28, s29
    s_mul_i32 s26, s26, 0
    s_lshl_b32 s28, s26, 10
    v_add_u32 v71, s28, v68
    s_add_u32 s28, s28, 4096
    s_cmp_eq_u32 s28, 12288
    s_cselect_b32 s28, 0, s28
    v_add_u32 v79, s28, v68
    s_add_u32 s28, s28, 4096
    s_cmp_eq_u32 s28, 12288
    s_cselect_b32 s28, 0, s28
    v_add_u32 v78, s28, v68
    s_mul_i32 s28, s22, 3
    s_add_u32 s28, s28, 12
    s_sub_u32 s26, s28, s26
    v_add_u32 v216, 4096, v68
    v_lshlrev_b32 v73, 3, v1
    v_xor_b32 v4, s74, v3
    v_lshrrev_b32 v5, 3, v2
    v_lshl_add_u32 v5, v4, 1, v5
    v_mul_u32_u24 v5, 768, v5
    v_and_b32 v4, 7, v2
    v_lshl_add_u32 v206, v4, 3, v5
    s_mul_i32 s14, s20, 24576
    s_mul_i32 s28, s22, 6144
    s_add_u32 s14, s14, s28
    s_add_u32 s14, s14, 503808
    s_mul_i32 s28, s22, 768
    s_add_u32 s28, s28, 151040
    v_lshlrev_b32 v4, 2, v1
    v_add_u32 v217, s28, v4
    v_lshlrev_b32 v244, 3, v2
    v_lshlrev_b32 v218, 4, v3
    v_add_u32 v219, s28, v218
    s_lshl_b32 s30, s20, 2
    s_add_u32 s30, s30, s22
    s_mul_i32 s30, s30, 49152
    s_add_u32 s30, s30, 1617920
    s_mul_i32 s28, s74, 12288
    s_add_u32 s76, s30, s28
    s_add_u32 s77, s76, 12288
    s_sub_u32 s78, s30, s28
    s_add_u32 s78, s78, 24576
    s_add_u32 s79, s78, 12288
    s_bfe_u32 s28, s21, 0x20002
    s_sub_u32 s81, s28, s22
    s_mul_i32 s81, s81, 49152
    s_add_u32 s81, s81, s76
    s_and_b32 s28, s22, 1
    s_mul_i32 s28, s28, 12288
    s_add_u32 s81, s81, s28
    s_and_b32 s28, s21, 3
    s_mul_i32 s28, s28, 3072
    s_add_u32 s81, s81, s28
    s_lshr_b32 s28, s22, 1
    s_lshl_b32 s28, s28, 10
    s_add_u32 s80, s28, s81
    s_lshl_b32 s19, s2, 7
    s_lshl_b32 s28, s22, 2
    s_add_u32 s19, s19, s28
    s_add_u32 s19, s19, 77824
    s_bfe_u32 s30, s21, 0x30001
    s_mul_i32 s66, s30, 73728
    s_mul_i32 s28, s22, 18432
    s_add_u32 s66, s66, s28
    s_add_u32 s66, s66, 1028096
    s_mul_i32 s15, s30, 3072
    s_add_u32 s15, s15, 6336512
    s_and_b32 s29, s21, 1
    s_lshl_b32 s28, s29, 10
    s_add_u32 s67, s66, s28
    s_lshl_b32 s28, s29, 12
    s_add_u32 s66, s66, s28
    s_lshl_b32 s28, s29, 9
    s_add_u32 s16, s15, s28
    s_lshl_b32 s28, s29, 11
    s_add_u32 s15, s15, s28
    s_lshl_b32 s18, s20, 2
    s_add_u32 s18, s18, s74
    s_lshl_b32 s18, s18, 1
    s_add_u32 s18, s18, s22
    s_mul_i32 s3, s18, 24576
    s_mul_i32 s28, s30, 3072
    s_add_u32 s3, s3, s28
    s_add_u32 s3, s3, 3190784
    s_lshl_b32 s28, s29, 3
    s_add_u32 s17, s3, s28
    s_add_u32 s17, s17, 1024
    s_lshl_b32 s28, s29, 11
    s_add_u32 s3, s3, s28
    s_lshl_b32 s18, s18, 10
    s_lshl_b32 s28, s30, 7
    s_add_u32 s18, s18, s28
    s_lshl_b32 s28, s29, 2
    s_add_u32 s18, s18, s28
    s_add_u32 s18, s18, 6483968
    s_bitcmp0_b32 s21, 3
    s_cbranch_scc1 L_p2s_22
    s_lshl_b32 s3, s20, 2
    s_add_u32 s3, s3, s30
    s_sub_u32 s3, s3, 4
    s_mul_i32 s3, s3, 49152
    s_lshl_b32 s28, s22, 2
    s_add_u32 s28, s28, s74
    s_mul_i32 s28, s28, 3072
    s_add_u32 s3, s3, s28
    s_add_u32 s3, s3, 4763648
    s_lshl_b32 s28, s29, 10
    s_add_u32 s17, s3, s28
    s_lshl_b32 s28, s29, 12
    s_add_u32 s3, s3, s28
L_p2s_22:
    s_and_b32 s65, s21, 3
    s_bfe_u32 s64, s21, 0x20002
    s_lshl_b32 s4, s20, 7
    s_add_u32 s4, s4, 77824
    v_and_b32 v6, 7, v1
    v_lshlrev_b32 v6, 10, v6
    s_lshl_b32 s28, s74, 13
    s_lshl_b32 s29, s64, 2
    s_add_u32 s28, s28, s29
    v_add_u32 v188, s28, v6
    v_and_b32 v6, 1, v1
    v_lshlrev_b32 v6, 10, v6
    v_and_b32 v7, 2, v1
    v_lshl_add_u32 v6, v7, 13, v6
    s_lshl_b32 s28, s65, 11
    s_lshl_b32 s29, s22, 2
    s_add_u32 s28, s28, s29
    s_add_u32 s28, s28, 8192
    v_add_u32 v191, s28, v6
    s_lshl_b32 s11, s20, 2
    s_add_u32 s13, s11, s65
    s_add_u32 s11, s11, s74
    s_lshl_b32 s11, s11, 1
    s_add_u32 s11, s11, s64
    s_mul_i32 s0, s11, 24576
    s_mul_i32 s29, s22, 3072
    s_add_u32 s0, s0, s29
    s_add_u32 s0, s0, 3190784
    s_lshl_b32 s1, s11, 10
    s_add_u32 s1, s1, 6483968
    s_mul_i32 s75, s13, 49152
    s_mul_i32 s29, s22, 12288
    s_add_u32 s75, s75, s29
    s_add_u32 s75, s75, 4763648
    s_mul_i32 s29, s74, 3072
    s_add_u32 s72, s75, s29
    s_sub_u32 s75, s75, s29
    s_add_u32 s75, s75, 6144
    s_add_u32 s5, s0, 12288
    v_add_u32 v74, 98304, v68
    s_add_u32 s28, s26, 0
    s_cmp_ge_u32 s28, 12
    s_cselect_b32 s29, 12, 0
    s_sub_u32 s28, s28, s29
    s_mul_i32 s28, s28, 1024
    s_add_u32 m0, s28, 98304
    s_mov_b32 s8, m0
    s_add_u32 s28, s26, 1
    s_cmp_ge_u32 s28, 12
    s_cselect_b32 s29, 12, 0
    s_sub_u32 s28, s28, s29
    s_mul_i32 s28, s28, 1024
    s_add_u32 m0, s28, 97280
    s_mov_b32 s9, m0
    s_add_u32 s28, s26, 2
    s_cmp_ge_u32 s28, 12
    s_cselect_b32 s29, 12, 0
    s_sub_u32 s28, s28, s29
    s_mul_i32 s28, s28, 1024
    s_add_u32 m0, s28, 96256
    s_mov_b32 s10, m0
    v_bfe_u32 v6, v2, 1, 2
    v_xor_b32 v6, v6, v3
    v_lshl_add_u32 v6, v2, 2, v6
    v_lshlrev_b32 v6, 4, v6
    s_lshl_b32 s28, s22, 11
    v_add_u32 v75, s28, v6
    s_lshl_b32 s28, s22, 8
    s_add_u32 s28, s28, 150016
    v_lshlrev_b32 v7, 3, v2
    v_add_u32 v76, s28, v7
    s_and_b32 s13, s22, 1
    s_lshl_b32 s28, s13, 7
    s_add_u32 s28, s28, 150016
    v_lshrrev_b32 v8, 2, v1
    v_lshlrev_b32 v7, 3, v8
    v_add_u32 v77, s28, v7
    v_bfe_u32 v7, v1, 3, 2
    v_xor_b32 v7, v7, v1
    v_lshlrev_b32 v7, 4, v7
    s_lshl_b32 s28, s22, 13
    v_add_u32 v213, s28, v7
    v_and_b32 v7, 3, v1
    v_lshlrev_b32 v6, 4, v8
    v_lshl_add_u32 v190, v7, 8, v6
    s_lshl_b32 s7, s64, 2
    s_add_u32 s7, s7, s74
    s_add_u32 s7, s7, s13
    s_lshl_b32 s7, s7, 4
    s_lshl_b32 s29, s20, 8
    s_add_u32 s7, s7, s29
    s_mul_i32 s7, s7, 768
    s_mul_i32 s29, s65, 192
    s_add_u32 s7, s7, s29
    s_lshr_b32 s29, s22, 1
    s_lshl_b32 s29, s29, 6
    s_add_u32 s6, s29, s7
    v_mul_u32_u24 v8, 768, v8
    v_lshl_add_u32 v70, v7, 4, v8
    s_mov_b32 s31, 40000
L_pwsp_24:
    buffer_load_dword v11, v231, s[32:35], 0 offen sc1
    s_waitcnt vmcnt(0)
    v_cmp_ne_u32 vcc, s23, v11
    s_cbranch_vccz L_pwsp_ok_25
    s_sub_u32 s31, s31, 1
    s_cbranch_scc0 L_pwsp_24
L_pwsp_ok_25:
    s_mov_b32 s62, 1
    buffer_load_dwordx2 v[80:81], v73, s[32:35], s15 offen offset:0 sc1
    buffer_load_dwordx2 v[84:85], v73, s[32:35], s15 offen offset:512 sc1
    buffer_load_dwordx2 v[88:89], v73, s[32:35], s16 offen offset:1024 sc1
    s_add_u32 s28, s26, 0
    s_cmp_ge_u32 s28, 12
    s_cselect_b32 s29, 12, 0
    s_sub_u32 s28, s28, s29
    s_mul_i32 s28, s28, 3072
    s_add_u32 m0, s28, 0
    s_add_u32 s28, s66, 0
    s_add_u32 s29, s67, 0
    buffer_load_dwordx4 v68, s[32:35], s28 offen sc1 lds
    buffer_load_dwordx4 v68, s[32:35], s28 offen offset:1024 sc1 lds
    buffer_load_dwordx4 v68, s[32:35], s29 offen offset:2048 sc1 lds
    s_add_u32 s28, s26, 1
    s_cmp_ge_u32 s28, 12
    s_cselect_b32 s29, 12, 0
    s_sub_u32 s28, s28, s29
    s_mul_i32 s28, s28, 3072
    s_add_u32 m0, s28, 0
    s_add_u32 s28, s66, 6144
    s_add_u32 s29, s67, 6144
    buffer_load_dwordx4 v68, s[32:35], s28 offen sc1 lds
    buffer_load_dwordx4 v68, s[32:35], s28 offen offset:1024 sc1 lds
    buffer_load_dwordx4 v68, s[32:35], s29 offen offset:2048 sc1 lds
    s_add_u32 s28, s26, 2
    s_cmp_ge_u32 s28, 12
    s_cselect_b32 s29, 12, 0
    s_sub_u32 s28, s28, s29
    s_mul_i32 s28, s28, 3072
    s_add_u32 m0, s28, 0
    s_add_u32 s28, s66, 12288
    s_add_u32 s29, s67, 12288
    buffer_load_dwordx4 v68, s[32:35], s28 offen sc1 lds
    buffer_load_dwordx4 v68, s[32:35], s28 offen offset:1024 sc1 lds
    buffer_load_dwordx4 v68, s[32:35], s29 offen offset:2048 sc1 lds
    s_cmp_eq_u32 s62, 0
    s_cbranch_scc1 L_pxcd_ok_27
    s_mov_b32 s31, 40000
L_pxcd_26:
    buffer_load_dword v11, v230, s[32:35], 0 offen sc1
    s_waitcnt vmcnt(0)
    v_and_b32 v10, -8, v11
    v_cmp_ne_u32 vcc, s23, v10
    s_mov_b32 s62, vcc_lo
    v_cmp_ne_u32 vcc, s24, v11
    s_mov_b32 s61, vcc_lo
    s_cmp_eq_u32 s62, 0
    s_cbranch_scc1 L_pxcd_ok_27
    s_sub_u32 s31, s31, 1
    s_cbranch_scc0 L_pxcd_26
L_pxcd_ok_27:
    s_branch L_p2d
L_prod_out:
    buffer_load_dword v11, v230, s[32:35], 0 offen sc1
    buffer_load_dword v9, v231, s[32:35], 0 offen sc1
    s_lshr_b32 s74, s21, 4
    s_lshl_b32 s74, s74, 1
    s_and_b32 s28, s21, 15
    s_mul_i32 s29, s28, 43
    s_lshr_b32 s29, s29, 7
    s_mul_i32 s29, s29, 3
    s_sub_u32 s26, s28, s29
    s_mul_i32 s26, s26, 0
    s_lshl_b32 s28, s26, 10
    v_add_u32 v71, s28, v68
    s_add_u32 s28, s28, 4096
    s_cmp_eq_u32 s28, 12288
    s_cselect_b32 s28, 0, s28
    v_add_u32 v79, s28, v68
    s_add_u32 s28, s28, 4096
    s_cmp_eq_u32 s28, 12288
    s_cselect_b32 s28, 0, s28
    v_add_u32 v78, s28, v68
    s_mul_i32 s28, s22, 3
    s_add_u32 s28, s28, 12
    s_sub_u32 s26, s28, s26
    v_add_u32 v216, 4096, v68
    v_lshlrev_b32 v73, 3, v1
    v_xor_b32 v4, s74, v3
    v_lshrrev_b32 v5, 3, v2
    v_lshl_add_u32 v5, v4, 1, v5
    v_mul_u32_u24 v5, 768, v5
    v_and_b32 v4, 7, v2
    v_lshl_add_u32 v206, v4, 3, v5
    s_mul_i32 s14, s20, 24576
    s_mul_i32 s28, s22, 6144
    s_add_u32 s14, s14, s28
    s_add_u32 s14, s14, 503808
    s_mul_i32 s28, s22, 768
    s_add_u32 s28, s28, 151040
    v_lshlrev_b32 v4, 2, v1
    v_add_u32 v217, s28, v4
    v_lshlrev_b32 v244, 3, v2
    v_lshlrev_b32 v218, 4, v3
    v_add_u32 v219, s28, v218
    s_lshl_b32 s30, s20, 2
    s_add_u32 s30, s30, s22
    s_mul_i32 s30, s30, 49152
    s_add_u32 s30, s30, 1617920
    s_mul_i32 s28, s74, 12288
    s_add_u32 s76, s30, s28
    s_add_u32 s77, s76, 12288
    s_sub_u32 s78, s30, s28
    s_add_u32 s78, s78, 24576
    s_add_u32 s79, s78, 12288
    s_bfe_u32 s28, s21, 0x20002
    s_sub_u32 s81, s28, s22
    s_mul_i32 s81, s81, 49152
    s_add_u32 s81, s81, s76
    s_and_b32 s28, s22, 1
    s_mul_i32 s28, s28, 12288
    s_add_u32 s81, s81, s28
    s_and_b32 s28, s21, 3
    s_mul_i32 s28, s28, 3072
    s_add_u32 s81, s81, s28
    s_lshr_b32 s28, s22, 1
    s_lshl_b32 s28, s28, 10
    s_add_u32 s80, s28, s81
    s_lshl_b32 s19, s2, 7
    s_lshl_b32 s28, s22, 2
    s_add_u32 s19, s19, s28
    s_add_u32 s19, s19, 77824
    s_bfe_u32 s30, s21, 0x30001
    s_mul_i32 s66, s30, 73728
    s_mul_i32 s28, s22, 18432
    s_add_u32 s66, s66, s28
    s_add_u32 s66, s66, 1028096
    s_mul_i32 s15, s30, 3072
    s_add_u32 s15, s15, 6336512
    s_and_b32 s29, s21, 1
    s_lshl_b32 s28, s29, 10
    s_add_u32 s67, s66, s28
    s_lshl_b32 s28, s29, 12
    s_add_u32 s66, s66, s28
    s_lshl_b32 s28, s29, 9
    s_add_u32 s16, s15, s28
    s_lshl_b32 s28, s29, 11
    s_add_u32 s15, s15, s28
    s_lshl_b32 s18, s20, 2
    s_add_u32 s18, s18, s74
    s_lshl_b32 s18, s18, 1
    s_add_u32 s18, s18, s22
    s_mul_i32 s3, s18, 24576
    s_mul_i32 s28, s30, 3072
    s_add_u32 s3, s3, s28
    s_add_u32 s3, s3, 3190784
    s_lshl_b32 s28, s29, 3
    s_add_u32 s17, s3, s28
    s_add_u32 s17, s17, 1024
    s_lshl_b32 s28, s29, 11
    s_add_u32 s3, s3, s28
    s_lshl_b32 s18, s18, 10
    s_lshl_b32 s28, s30, 7
    s_add_u32 s18, s18, s28
    s_lshl_b32 s28, s29, 2
    s_add_u32 s18, s18, s28
    s_add_u32 s18, s18, 6483968
    s_bitcmp0_b32 s21, 3
    s_cbranch_scc1 L_p2s_27
    s_lshl_b32 s3, s20, 2
    s_add_u32 s3, s3, s30
    s_sub_u32 s3, s3, 4
    s_mul_i32 s3, s3, 49152
    s_lshl_b32 s28, s22, 2
    s_add_u32 s28, s28, s74
    s_mul_i32 s28, s28, 3072
    s_add_u32 s3, s3, s28
    s_add_u32 s3, s3, 4763648
    s_lshl_b32 s28, s29, 10
    s_add_u32 s17, s3, s28
    s_lshl_b32 s28, s29, 12
    s_add_u32 s3, s3, s28
L_p2s_27:
    s_and_b32 s65, s21, 3
    s_bfe_u32 s64, s21, 0x20002
    s_lshl_b32 s4, s20, 7
    s_add_u32 s4, s4, 77824
    v_and_b32 v6, 7, v1
    v_lshlrev_b32 v6, 10, v6
    s_lshl_b32 s28, s74, 13
    s_lshl_b32 s29, s64, 2
    s_add_u32 s28, s28, s29
    v_add_u32 v188, s28, v6
    v_and_b32 v6, 1, v1
    v_lshlrev_b32 v6, 10, v6
    v_and_b32 v7, 2, v1
    v_lshl_add_u32 v6, v7, 13, v6
    s_lshl_b32 s28, s65, 11
    s_lshl_b32 s29, s22, 2
    s_add_u32 s28, s28, s29
    s_add_u32 s28, s28, 8192
    v_add_u32 v191, s28, v6
    s_lshl_b32 s11, s20, 2
    s_add_u32 s13, s11, s65
    s_add_u32 s11, s11, s74
    s_lshl_b32 s11, s11, 1
    s_add_u32 s11, s11, s64
    s_mul_i32 s0, s11, 24576
    s_mul_i32 s29, s22, 3072
    s_add_u32 s0, s0, s29
    s_add_u32 s0, s0, 3190784
    s_lshl_b32 s1, s11, 10
    s_add_u32 s1, s1, 6483968
    s_mul_i32 s75, s13, 49152
    s_mul_i32 s29, s22, 12288
    s_add_u32 s75, s75, s29
    s_add_u32 s75, s75, 4763648
    s_mul_i32 s29, s74, 3072
    s_add_u32 s72, s75, s29
    s_sub_u32 s75, s75, s29
    s_add_u32 s75, s75, 6144
    s_add_u32 s5, s0, 12288
    v_add_u32 v74, 98304, v68
    s_add_u32 s28, s26, 0
    s_cmp_ge_u32 s28, 12
    s_cselect_b32 s29, 12, 0
    s_sub_u32 s28, s28, s29
    s_mul_i32 s28, s28, 1024
    s_add_u32 m0, s28, 98304
    s_mov_b32 s8, m0
    s_add_u32 s28, s26, 1
    s_cmp_ge_u32 s28, 12
    s_cselect_b32 s29, 12, 0
    s_sub_u32 s28, s28, s29
    s_mul_i32 s28, s28, 1024
    s_add_u32 m0, s28, 97280
    s_mov_b32 s9, m0
    s_add_u32 s28, s26, 2
    s_cmp_ge_u32 s28, 12
    s_cselect_b32 s29, 12, 0
    s_sub_u32 s28, s28, s29
    s_mul_i32 s28, s28, 1024
    s_add_u32 m0, s28, 96256
    s_mov_b32 s10, m0
    v_bfe_u32 v6, v2, 1, 2
    v_xor_b32 v6, v6, v3
    v_lshl_add_u32 v6, v2, 2, v6
    v_lshlrev_b32 v6, 4, v6
    s_lshl_b32 s28, s22, 11
    v_add_u32 v75, s28, v6
    s_lshl_b32 s28, s22, 8
    s_add_u32 s28, s28, 150016
    v_lshlrev_b32 v7, 3, v2
    v_add_u32 v76, s28, v7
    s_and_b32 s13, s22, 1
    s_lshl_b32 s28, s13, 7
    s_add_u32 s28, s28, 150016
    v_lshrrev_b32 v8, 2, v1
    v_lshlrev_b32 v7, 3, v8
    v_add_u32 v77, s28, v7
    v_bfe_u32 v7, v1, 3, 2
    v_xor_b32 v7, v7, v1
    v_lshlrev_b32 v7, 4, v7
    s_lshl_b32 s28, s22, 13
    v_add_u32 v213, s28, v7
    v_and_b32 v7, 3, v1
    v_lshlrev_b32 v6, 4, v8
    v_lshl_add_u32 v190, v7, 8, v6
    s_lshl_b32 s7, s64, 2
    s_add_u32 s7, s7, s74
    s_add_u32 s7, s7, s13
    s_lshl_b32 s7, s7, 4
    s_lshl_b32 s29, s20, 8
    s_add_u32 s7, s7, s29
    s_mul_i32 s7, s7, 768
    s_mul_i32 s29, s65, 192
    s_add_u32 s7, s7, s29
    s_lshr_b32 s29, s22, 1
    s_lshl_b32 s29, s29, 6
    s_add_u32 s6, s29, s7
    v_mul_u32_u24 v8, 768, v8
    v_lshl_add_u32 v70, v7, 4, v8
    s_waitcnt vmcnt(0)
    v_and_b32 v10, -8, v11
    v_cmp_ne_u32 vcc, s23, v10
    s_mov_b32 s62, vcc_lo
    v_cmp_ne_u32 vcc, s24, v11
    s_mov_b32 s61, vcc_lo
    s_cmp_eq_u32 s62, 0
    s_cbranch_scc1 L_pxcc_ok_30
    s_mov_b32 s31, 40000
L_pxcc_29:
    buffer_load_dword v11, v230, s[32:35], 0 offen sc1
    s_waitcnt vmcnt(0)
    v_and_b32 v10, -8, v11
    v_cmp_ne_u32 vcc, s23, v10
    s_mov_b32 s62, vcc_lo
    v_cmp_ne_u32 vcc, s24, v11
    s_mov_b32 s61, vcc_lo
    s_cmp_eq_u32 s62, 0
    s_cbranch_scc1 L_pxcc_ok_30
    s_sub_u32 s31, s31, 1
    s_cbranch_scc0 L_pxcc_29
L_pxcc_ok_30:
    v_cmp_ne_u32 vcc, s23, v9
    s_cbranch_vccz L_prod_go
    s_mov_b32 s31, 40000
L_pwsq_31:
    buffer_load_dword v11, v231, s[32:35], 0 offen sc1
    s_waitcnt vmcnt(0)
    v_cmp_ne_u32 vcc, s23, v11
    s_cbranch_vccz L_pwsq_ok_32
    s_sub_u32 s31, s31, 1
    s_cbranch_scc0 L_pwsq_31
L_pwsq_ok_32:
L_prod_go:
    buffer_load_dwordx2 v[80:81], v73, s[32:35], s15 offen offset:0 sc1
    buffer_load_dwordx2 v[84:85], v73, s[32:35], s15 offen offset:512 sc1
    buffer_load_dwordx2 v[88:89], v73, s[32:35], s16 offen offset:1024 sc1
    s_add_u32 s28, s26, 0
    s_cmp_ge_u32 s28, 12
    s_cselect_b32 s29, 12, 0
    s_sub_u32 s28, s28, s29
    s_mul_i32 s28, s28, 3072
    s_add_u32 m0, s28, 0
    s_add_u32 s28, s66, 0
    s_add_u32 s29, s67, 0
    buffer_load_dwordx4 v68, s[32:35], s28 offen sc1 lds
    buffer_load_dwordx4 v68, s[32:35], s28 offen offset:1024 sc1 lds
    buffer_load_dwordx4 v68, s[32:35], s29 offen offset:2048 sc1 lds
    s_add_u32 s28, s26, 1
    s_cmp_ge_u32 s28, 12
    s_cselect_b32 s29, 12, 0
    s_sub_u32 s28, s28, s29
    s_mul_i32 s28, s28, 3072
    s_add_u32 m0, s28, 0
    s_add_u32 s28, s66, 6144
    s_add_u32 s29, s67, 6144
    buffer_load_dwordx4 v68, s[32:35], s28 offen sc1 lds
    buffer_load_dwordx4 v68, s[32:35], s28 offen offset:1024 sc1 lds
    buffer_load_dwordx4 v68, s[32:35], s29 offen offset:2048 sc1 lds
    s_add_u32 s28, s26, 2
    s_cmp_ge_u32 s28, 12
    s_cselect_b32 s29, 12, 0
    s_sub_u32 s28, s28, s29
    s_mul_i32 s28, s28, 3072
    s_add_u32 m0, s28, 0
    s_add_u32 s28, s66, 12288
    s_add_u32 s29, s67, 12288
    buffer_load_dwordx4 v68, s[32:35], s28 offen sc1 lds
    buffer_load_dwordx4 v68, s[32:35], s28 offen offset:1024 sc1 lds
    buffer_load_dwordx4 v68, s[32:35], s29 offen offset:2048 sc1 lds
    s_waitcnt vmcnt(0)
    s_branch L_p2d
L_prod3_body:
    s_mov_b32 s32, s18
    s_mov_b32 s33, s19
    s_mov_b32 s44, s14
    s_mov_b32 s45, s15
    s_mov_b32 s46, 1572864
    s_mov_b32 s47, 0x20000
    s_mov_b32 s58, 0x3f803f80
    s_getreg_b32 s24, hwreg(HW_REG_XCC_ID, 0, 3)
    v_mov_b32 v12, s58
    v_mov_b32 v13, s58
    v_mov_b32 v14, s58
    v_mov_b32 v15, s58
    v_mov_b32 v69, 0xffffff00
    v_mov_b32 v228, 0
    v_cmp_eq_u32 s[50:51], 0, v3
    v_lshrrev_b32 v4, 1, v3
    v_lshrrev_b32 v5, 3, v2
    v_cmp_eq_u32 s[48:49], v4, v5
    v_lshrrev_b32 v5, 2, v2
    v_cmp_eq_u32 s[100:101], v3, v5
    s_lshl_b32 s27, s20, 7
    s_add_u32 s27, s27, 4096
    v_and_b32 v5, 31, v1
    v_lshlrev_b32 v5, 10, v5
    v_add_u32 v230, s27, v5
    v_min_u32 v231, 11, v1
    s_mul_i32 s28, s20, 12288
    v_lshlrev_b32 v231, 7, v231
    s_bitcmp0_b32 s21, 3
    s_cselect_b32 s27, 0, 1536
    s_add_u32 s27, s27, 6390272
    s_add_u32 s27, s27, s28
    v_add_u32 v231, s27, v231
    v_min_u32 v4, 5, v1
    v_mul_u32_u24 v4, 768, v4
    s_lshl_b32 s27, s60, 7
    s_add_u32 s27, s27, s28
    s_add_u32 s27, s27, 6385664
    v_add_u32 v246, s27, v4
    v_lshrrev_b32 v4, 2, v2
    v_and_b32 v4, 1, v4
    v_lshlrev_b32 v4, 10, v4
    v_lshrrev_b32 v5, 1, v3
    v_lshl_add_u32 v4, v5, 8, v4
    v_and_b32 v5, 1, v3
    v_lshl_add_u32 v4, v5, 7, v4
    v_lshrrev_b32 v5, 3, v2
    v_lshl_add_u32 v4, v5, 6, v4
    v_and_b32 v5, 3, v2
    v_lshl_add_u32 v9, v5, 4, v4
    s_and_b32 s28, s22, 1
    s_lshl_b32 s28, s28, 9
    v_add_u32 v9, s28, v9
    s_lshl_b32 s25, s64, 7
    s_add_u32 s25, s25, 6385664
    s_lshr_b32 s27, s22, 1
    s_lshl_b32 s28, s66, 1
    s_add_u32 s30, s27, s28
    v_lshrrev_b32 v4, 1, v2
    v_xor_b32 v4, v4, v3
    v_lshlrev_b32 v4, 4, v4
    v_lshl_add_u32 v7, v2, 7, v4
    s_add_u32 s27, s68, 49152
    v_add_u32 v70, s27, v7
    v_xor_b32 v71, 64, v70
    v_add_u32 v72, 49152, v70
    v_add_u32 v73, 49152, v71
    s_mul_i32 s27, s30, 6144
    s_sub_u32 s28, s65, 1
    s_mul_i32 s28, s28, 294912
    s_add_u32 s27, s27, s28
    s_add_u32 s27, s27, 1028096
    s_sub_u32 s28, s65, 1
    s_mul_i32 s29, s28, 12288
    s_cmp_eq_u32 s66, 0
    s_cselect_b32 s28, 0, 256
    s_add_u32 s29, s29, s28
    s_lshr_b32 s28, s22, 1
    s_lshl_b32 s28, s28, 7
    s_add_u32 s29, s29, s28
    s_and_b32 s28, s22, 1
    s_lshl_b32 s28, s28, 2
    s_add_u32 s29, s29, s28
    s_add_u32 s29, s29, 6336512
    v_bfe_u32 v4, v2, 2, 1
    v_lshlrev_b32 v4, 9, v4
    v_lshrrev_b32 v5, 1, v3
    v_lshl_add_u32 v4, v5, 6, v4
    v_lshrrev_b32 v5, 3, v2
    v_lshl_add_u32 v4, v5, 5, v4
    v_and_b32 v6, 3, v2
    v_lshl_add_u32 v212, v6, 3, v4
    v_and_b32 v4, 1, v3
    v_cmp_eq_u32 vcc, v4, v5
    s_nop 1
    v_cndmask_b32 v208, 0, v12, vcc
    v_cndmask_b32 v209, 0, v12, vcc
    v_cndmask_b32 v210, 0, v12, vcc
    v_cndmask_b32 v211, 0, v12, vcc
    s_lshl_b32 s30, s67, 1
    s_add_u32 s30, s30, 0
    s_mul_hi_u32 s16, s30, 1431655766
    s_mul_i32 s28, s16, 3
    s_lshl_b32 s71, s30, 10
    s_add_u32 s71, s71, s29
    s_sub_u32 s30, s30, s28
    s_mul_i32 s16, s16, 73728
    s_lshl_b32 s30, s30, 11
    s_add_u32 s16, s16, s30
    s_add_u32 s16, s16, s27
    s_lshl_b32 s30, s67, 1
    s_add_u32 s30, s30, 1
    s_mul_hi_u32 s17, s30, 1431655766
    s_mul_i32 s28, s17, 3
    s_lshl_b32 s72, s30, 10
    s_add_u32 s72, s72, s29
    s_sub_u32 s30, s30, s28
    s_mul_i32 s17, s17, 73728
    s_lshl_b32 s30, s30, 11
    s_add_u32 s17, s17, s30
    s_add_u32 s17, s17, s27
    s_waitcnt lgkmcnt(0)
    s_and_b32 s27, s23, 0x78787878
    s_add_u32 s27, s27, 0x08080808
    s_and_b32 s28, s23, 0x80808080
    s_xor_b32 s23, s27, s28
    s_or_b32 s24, s24, s23
    s_lshl_b32 s27, s2, 7
    s_add_u32 s27, s27, 4096
    v_mov_b32 v4, s24
    v_mov_b32 v229, s23
    s_mov_b64 exec, 1
    buffer_store_dword v4, v228, s[32:35], s27 offen sc1
    s_mov_b64 exec, -1
    s_and_b32 s52, s23, 0xff
    s_bfe_u32 s53, s23, 0x80008
    s_bfe_u32 s54, s23, 0x80010
    s_lshr_b32 s55, s23, 24
    v_mul_u32_u24 v4, 12288, v1
    s_mov_b64 exec, 0xff
    buffer_load_dword v254, v4, s[32:35], s25 offen sc1
    s_mov_b64 exec, -1
    buffer_load_dword v254, v212, s[32:35], s71 offen sc1
    buffer_load_dword v254, v212, s[32:35], s72 offen sc1
    s_add_u32 m0, s68, 8192
    s_add_u32 s27, s63, 128
    buffer_load_dwordx4 v200, s[40:43], s61 offen lds
    buffer_load_dwordx4 v201, s[40:43], s61 offen offset:1024 lds
    s_add_u32 m0, s68, 73728
    s_add_u32 s61, s61, s26
    buffer_load_dwordx4 v206, s[36:39], s27 offen lds
    buffer_load_dwordx4 v207, s[36:39], s27 offen offset:1024 lds
    s_add_u32 m0, s68, 81920
    s_add_u32 s27, s27, 147456
    buffer_load_dwordx4 v206, s[36:39], s27 offen lds
    buffer_load_dwordx4 v207, s[36:39], s27 offen offset:1024 lds
    s_add_u32 m0, s68, 90112
    s_add_u32 s27, s27, 147456
    buffer_load_dwordx4 v206, s[36:39], s27 offen lds
    buffer_load_dwordx4 v207, s[36:39], s27 offen offset:1024 lds
    s_cmp_eq_u32 s65, 1
    s_cbranch_scc1 L_prod_rows
    v_lshlrev_b32 v4, 10, v3
    v_lshrrev_b32 v6, 2, v2
    v_lshl_add_u32 v4, v6, 7, v4
    v_and_b32 v5, 1, v3
    v_lshrrev_b32 v6, 3, v2
    v_lshl_or_b32 v6, v5, 1, v6
    v_lshl_add_u32 v4, v6, 5, v4
    v_and_b32 v6, 3, v2
    v_lshl_add_u32 v74, v6, 3, v4
    v_xor_b32 v75, 32, v74
    v_xor_b32 v76, 64, v74
    v_xor_b32 v77, 96, v74
    s_waitcnt vmcnt(12)
    s_barrier
    s_add_u32 m0, s68, 16384
    s_add_u32 s27, s63, 256
    buffer_load_dwordx4 v200, s[40:43], s61 offen lds
    ds_read_b64_tr_b16 v[80:81], v74 offset:0
    ds_read_b64_tr_b16 v[82:83], v74 offset:512
    ds_read_b128 v[16:19], v70 offset:0
    ds_read_b128 v[20:23], v70 offset:8192
    ds_read_b128 v[24:27], v70 offset:16384
    buffer_load_dwordx4 v201, s[40:43], s61 offen offset:1024 lds
    ds_read_b64_tr_b16 v[84:85], v75 offset:0
    ds_read_b64_tr_b16 v[86:87], v75 offset:512
    s_add_u32 m0, s68, 98304
    s_add_u32 s61, s61, s26
    buffer_load_dwordx4 v206, s[36:39], s27 offen lds
    ds_read_b64_tr_b16 v[88:89], v76 offset:0
    ds_read_b64_tr_b16 v[90:91], v76 offset:512
    buffer_load_dwordx4 v207, s[36:39], s27 offen offset:1024 lds
    ds_read_b64_tr_b16 v[92:93], v77 offset:0
    ds_read_b64_tr_b16 v[94:95], v77 offset:512
    s_waitcnt lgkmcnt(6)
    v_mfma_f32_16x16x32_bf16 v[144:147], v[16:19], v[80:83], 0
    v_mfma_f32_16x16x32_bf16 v[160:163], v[20:23], v[80:83], 0
    v_mfma_f32_16x16x32_bf16 v[176:179], v[24:27], v[80:83], 0
    s_add_u32 m0, s68, 106496
    s_add_u32 s27, s27, 147456
    buffer_load_dwordx4 v206, s[36:39], s27 offen lds
    ds_read_b64_tr_b16 v[96:97], v74 offset:4096
    ds_read_b64_tr_b16 v[98:99], v74 offset:4608
    ds_read_b128 v[28:31], v71 offset:0
    ds_read_b128 v[32:35], v71 offset:8192
    ds_read_b128 v[36:39], v71 offset:16384
    buffer_load_dwordx4 v207, s[36:39], s27 offen offset:1024 lds
    ds_read_b64_tr_b16 v[100:101], v75 offset:4096
    ds_read_b64_tr_b16 v[102:103], v75 offset:4608
    s_waitcnt lgkmcnt(11)
    v_mfma_f32_16x16x32_bf16 v[148:151], v[16:19], v[84:87], 0
    v_mfma_f32_16x16x32_bf16 v[164:167], v[20:23], v[84:87], 0
    v_mfma_f32_16x16x32_bf16 v[180:183], v[24:27], v[84:87], 0
    s_add_u32 m0, s68, 114688
    s_add_u32 s27, s27, 147456
    buffer_load_dwordx4 v206, s[36:39], s27 offen lds
    ds_read_b64_tr_b16 v[104:105], v76 offset:4096
    ds_read_b64_tr_b16 v[106:107], v76 offset:4608
    s_waitcnt lgkmcnt(11)
    v_mfma_f32_16x16x32_bf16 v[152:155], v[16:19], v[88:91], 0
    v_mfma_f32_16x16x32_bf16 v[168:171], v[20:23], v[88:91], 0
    v_mfma_f32_16x16x32_bf16 v[184:187], v[24:27], v[88:91], 0
    buffer_load_dwordx4 v207, s[36:39], s27 offen offset:1024 lds
    ds_read_b64_tr_b16 v[108:109], v77 offset:4096
    ds_read_b64_tr_b16 v[110:111], v77 offset:4608
    s_waitcnt lgkmcnt(11)
    v_mfma_f32_16x16x32_bf16 v[156:159], v[16:19], v[92:95], 0
    v_mfma_f32_16x16x32_bf16 v[172:175], v[20:23], v[92:95], 0
    v_mfma_f32_16x16x32_bf16 v[188:191], v[24:27], v[92:95], 0
    s_waitcnt lgkmcnt(6)
    v_mfma_f32_16x16x32_bf16 v[144:147], v[28:31], v[96:99], v[144:147]
    v_mfma_f32_16x16x32_bf16 v[160:163], v[32:35], v[96:99], v[160:163]
    v_mfma_f32_16x16x32_bf16 v[176:179], v[36:39], v[96:99], v[176:179]
    s_waitcnt vmcnt(8)
    s_barrier
    s_add_u32 m0, s68, 24576
    s_add_u32 s27, s63, 384
    buffer_load_dwordx4 v200, s[40:43], s61 offen lds
    ds_read_b64_tr_b16 v[112:113], v74 offset:8192
    ds_read_b64_tr_b16 v[114:115], v74 offset:8704
    ds_read_b128 v[40:43], v70 offset:24576
    ds_read_b128 v[44:47], v70 offset:32768
    ds_read_b128 v[48:51], v70 offset:40960
    buffer_load_dwordx4 v201, s[40:43], s61 offen offset:1024 lds
    ds_read_b64_tr_b16 v[116:117], v75 offset:8192
    ds_read_b64_tr_b16 v[118:119], v75 offset:8704
    s_waitcnt lgkmcnt(11)
    v_mfma_f32_16x16x32_bf16 v[148:151], v[28:31], v[100:103], v[148:151]
    v_mfma_f32_16x16x32_bf16 v[164:167], v[32:35], v[100:103], v[164:167]
    v_mfma_f32_16x16x32_bf16 v[180:183], v[36:39], v[100:103], v[180:183]
    s_add_u32 m0, s68, 122880
    s_add_u32 s61, s61, s26
    buffer_load_dwordx4 v206, s[36:39], s27 offen lds
    ds_read_b64_tr_b16 v[120:121], v76 offset:8192
    ds_read_b64_tr_b16 v[122:123], v76 offset:8704
    s_waitcnt lgkmcnt(11)
    v_mfma_f32_16x16x32_bf16 v[152:155], v[28:31], v[104:107], v[152:155]
    v_mfma_f32_16x16x32_bf16 v[168:171], v[32:35], v[104:107], v[168:171]
    v_mfma_f32_16x16x32_bf16 v[184:187], v[36:39], v[104:107], v[184:187]
    buffer_load_dwordx4 v207, s[36:39], s27 offen offset:1024 lds
    ds_read_b64_tr_b16 v[124:125], v77 offset:8192
    ds_read_b64_tr_b16 v[126:127], v77 offset:8704
    s_waitcnt lgkmcnt(11)
    v_mfma_f32_16x16x32_bf16 v[156:159], v[28:31], v[108:111], v[156:159]
    v_mfma_f32_16x16x32_bf16 v[172:175], v[32:35], v[108:111], v[172:175]
    v_mfma_f32_16x16x32_bf16 v[188:191], v[36:39], v[108:111], v[188:191]
    s_waitcnt lgkmcnt(6)
    v_mfma_f32_16x16x32_bf16 v[144:147], v[40:43], v[112:115], v[144:147]
    v_mfma_f32_16x16x32_bf16 v[160:163], v[44:47], v[112:115], v[160:163]
    v_mfma_f32_16x16x32_bf16 v[176:179], v[48:51], v[112:115], v[176:179]
    s_add_u32 m0, s68, 131072
    s_add_u32 s27, s27, 147456
    buffer_load_dwordx4 v206, s[36:39], s27 offen lds
    ds_read_b64_tr_b16 v[128:129], v74 offset:12288
    ds_read_b64_tr_b16 v[130:131], v74 offset:12800
    ds_read_b128 v[52:55], v71 offset:24576
    ds_read_b128 v[56:59], v71 offset:32768
    ds_read_b128 v[60:63], v71 offset:40960
    buffer_load_dwordx4 v207, s[36:39], s27 offen offset:1024 lds
    ds_read_b64_tr_b16 v[132:133], v75 offset:12288
    ds_read_b64_tr_b16 v[134:135], v75 offset:12800
    s_waitcnt lgkmcnt(11)
    v_mfma_f32_16x16x32_bf16 v[148:151], v[40:43], v[116:119], v[148:151]
    v_mfma_f32_16x16x32_bf16 v[164:167], v[44:47], v[116:119], v[164:167]
    v_mfma_f32_16x16x32_bf16 v[180:183], v[48:51], v[116:119], v[180:183]
    s_add_u32 m0, s68, 139264
    s_add_u32 s27, s27, 147456
    buffer_load_dwordx4 v206, s[36:39], s27 offen lds
    ds_read_b64_tr_b16 v[136:137], v76 offset:12288
    ds_read_b64_tr_b16 v[138:139], v76 offset:12800
    s_waitcnt lgkmcnt(11)
    v_mfma_f32_16x16x32_bf16 v[152:155], v[40:43], v[120:123], v[152:155]
    v_mfma_f32_16x16x32_bf16 v[168:171], v[44:47], v[120:123], v[168:171]
    v_mfma_f32_16x16x32_bf16 v[184:187], v[48:51], v[120:123], v[184:187]
    buffer_load_dwordx4 v207, s[36:39], s27 offen offset:1024 lds
    ds_read_b64_tr_b16 v[140:141], v77 offset:12288
    ds_read_b64_tr_b16 v[142:143], v77 offset:12800
    s_waitcnt lgkmcnt(11)
    v_mfma_f32_16x16x32_bf16 v[156:159], v[40:43], v[124:127], v[156:159]
    v_mfma_f32_16x16x32_bf16 v[172:175], v[44:47], v[124:127], v[172:175]
    v_mfma_f32_16x16x32_bf16 v[188:191], v[48:51], v[124:127], v[188:191]
    s_waitcnt lgkmcnt(6)
    v_mfma_f32_16x16x32_bf16 v[144:147], v[52:55], v[128:131], v[144:147]
    v_mfma_f32_16x16x32_bf16 v[160:163], v[56:59], v[128:131], v[160:163]
    v_mfma_f32_16x16x32_bf16 v[176:179], v[60:63], v[128:131], v[176:179]
    s_waitcnt vmcnt(8)
    s_barrier
    s_add_u32 m0, s68, 32768
    s_add_u32 s27, s63, 512
    buffer_load_dwordx4 v200, s[40:43], s61 offen lds
    ds_read_b64_tr_b16 v[80:81], v74 offset:16384
    ds_read_b64_tr_b16 v[82:83], v74 offset:16896
    ds_read_b128 v[16:19], v72 offset:0
    ds_read_b128 v[20:23], v72 offset:8192
    ds_read_b128 v[24:27], v72 offset:16384
    buffer_load_dwordx4 v201, s[40:43], s61 offen offset:1024 lds
    ds_read_b64_tr_b16 v[84:85], v75 offset:16384
    ds_read_b64_tr_b16 v[86:87], v75 offset:16896
    s_waitcnt lgkmcnt(11)
    v_mfma_f32_16x16x32_bf16 v[148:151], v[52:55], v[132:135], v[148:151]
    v_mfma_f32_16x16x32_bf16 v[164:167], v[56:59], v[132:135], v[164:167]
    v_mfma_f32_16x16x32_bf16 v[180:183], v[60:63], v[132:135], v[180:183]
    s_add_u32 m0, s68, 49152
    s_add_u32 s61, s61, s26
    buffer_load_dwordx4 v206, s[36:39], s27 offen lds
    ds_read_b64_tr_b16 v[88:89], v76 offset:16384
    ds_read_b64_tr_b16 v[90:91], v76 offset:16896
    s_waitcnt lgkmcnt(11)
    v_mfma_f32_16x16x32_bf16 v[152:155], v[52:55], v[136:139], v[152:155]
    v_mfma_f32_16x16x32_bf16 v[168:171], v[56:59], v[136:139], v[168:171]
    v_mfma_f32_16x16x32_bf16 v[184:187], v[60:63], v[136:139], v[184:187]
    buffer_load_dwordx4 v207, s[36:39], s27 offen offset:1024 lds
    ds_read_b64_tr_b16 v[92:93], v77 offset:16384
    ds_read_b64_tr_b16 v[94:95], v77 offset:16896
    s_waitcnt lgkmcnt(11)
    v_mfma_f32_16x16x32_bf16 v[156:159], v[52:55], v[140:143], v[156:159]
    v_mfma_f32_16x16x32_bf16 v[172:175], v[56:59], v[140:143], v[172:175]
    v_mfma_f32_16x16x32_bf16 v[188:191], v[60:63], v[140:143], v[188:191]
    s_waitcnt lgkmcnt(6)
    v_mfma_f32_16x16x32_bf16 v[144:147], v[16:19], v[80:83], v[144:147]
    v_mfma_f32_16x16x32_bf16 v[160:163], v[20:23], v[80:83], v[160:163]
    v_mfma_f32_16x16x32_bf16 v[176:179], v[24:27], v[80:83], v[176:179]
    s_add_u32 m0, s68, 57344
    s_add_u32 s27, s27, 147456
    buffer_load_dwordx4 v206, s[36:39], s27 offen lds
    ds_read_b64_tr_b16 v[96:97], v74 offset:20480
    ds_read_b64_tr_b16 v[98:99], v74 offset:20992
    ds_read_b128 v[28:31], v73 offset:0
    ds_read_b128 v[32:35], v73 offset:8192
    ds_read_b128 v[36:39], v73 offset:16384
    buffer_load_dwordx4 v207, s[36:39], s27 offen offset:1024 lds
    ds_read_b64_tr_b16 v[100:101], v75 offset:20480
    ds_read_b64_tr_b16 v[102:103], v75 offset:20992
    s_waitcnt lgkmcnt(11)
    v_mfma_f32_16x16x32_bf16 v[148:151], v[16:19], v[84:87], v[148:151]
    v_mfma_f32_16x16x32_bf16 v[164:167], v[20:23], v[84:87], v[164:167]
    v_mfma_f32_16x16x32_bf16 v[180:183], v[24:27], v[84:87], v[180:183]
    s_add_u32 m0, s68, 65536
    s_add_u32 s27, s27, 147456
    buffer_load_dwordx4 v206, s[36:39], s27 offen lds
    ds_read_b64_tr_b16 v[104:105], v76 offset:20480
    ds_read_b64_tr_b16 v[106:107], v76 offset:20992
    s_waitcnt lgkmcnt(11)
    v_mfma_f32_16x16x32_bf16 v[152:155], v[16:19], v[88:91], v[152:155]
    v_mfma_f32_16x16x32_bf16 v[168:171], v[20:23], v[88:91], v[168:171]
    v_mfma_f32_16x16x32_bf16 v[184:187], v[24:27], v[88:91], v[184:187]
    buffer_load_dwordx4 v207, s[36:39], s27 offen offset:1024 lds
    ds_read_b64_tr_b16 v[108:109], v77 offset:20480
    ds_read_b64_tr_b16 v[110:111], v77 offset:20992
    s_waitcnt lgkmcnt(11)
    v_mfma_f32_16x16x32_bf16 v[156:159], v[16:19], v[92:95], v[156:159]
    v_mfma_f32_16x16x32_bf16 v[172:175], v[20:23], v[92:95], v[172:175]
    v_mfma_f32_16x16x32_bf16 v[188:191], v[24:27], v[92:95], v[188:191]
    s_waitcnt lgkmcnt(6)
    v_mfma_f32_16x16x32_bf16 v[144:147], v[28:31], v[96:99], v[144:147]
    v_mfma_f32_16x16x32_bf16 v[160:163], v[32:35], v[96:99], v[160:163]
    v_mfma_f32_16x16x32_bf16 v[176:179], v[36:39], v[96:99], v[176:179]
    s_waitcnt vmcnt(8)
    s_barrier
    s_add_u32 m0, s68, 40960
    s_add_u32 s27, s63, 640
    buffer_load_dwordx4 v200, s[40:43], s61 offen lds
    ds_read_b64_tr_b16 v[112:113], v74 offset:24576
    ds_read_b64_tr_b16 v[114:115], v74 offset:25088
    ds_read_b128 v[40:43], v72 offset:24576
    ds_read_b128 v[44:47], v72 offset:32768
    ds_read_b128 v[48:51], v72 offset:40960
    buffer_load_dwordx4 v201, s[40:43], s61 offen offset:1024 lds
    ds_read_b64_tr_b16 v[116:117], v75 offset:24576
    ds_read_b64_tr_b16 v[118:119], v75 offset:25088
    s_waitcnt lgkmcnt(11)
    v_mfma_f32_16x16x32_bf16 v[148:151], v[28:31], v[100:103], v[148:151]
    v_mfma_f32_16x16x32_bf16 v[164:167], v[32:35], v[100:103], v[164:167]
    v_mfma_f32_16x16x32_bf16 v[180:183], v[36:39], v[100:103], v[180:183]
    s_add_u32 m0, s68, 73728
    s_add_u32 s61, s61, s26
    buffer_load_dwordx4 v206, s[36:39], s27 offen lds
    ds_read_b64_tr_b16 v[120:121], v76 offset:24576
    ds_read_b64_tr_b16 v[122:123], v76 offset:25088
    s_waitcnt lgkmcnt(11)
    v_mfma_f32_16x16x32_bf16 v[152:155], v[28:31], v[104:107], v[152:155]
    v_mfma_f32_16x16x32_bf16 v[168:171], v[32:35], v[104:107], v[168:171]
    v_mfma_f32_16x16x32_bf16 v[184:187], v[36:39], v[104:107], v[184:187]
    buffer_load_dwordx4 v207, s[36:39], s27 offen offset:1024 lds
    ds_read_b64_tr_b16 v[124:125], v77 offset:24576
    ds_read_b64_tr_b16 v[126:127], v77 offset:25088
    s_waitcnt lgkmcnt(11)
    v_mfma_f32_16x16x32_bf16 v[156:159], v[28:31], v[108:111], v[156:159]
    v_mfma_f32_16x16x32_bf16 v[172:175], v[32:35], v[108:111], v[172:175]
    v_mfma_f32_16x16x32_bf16 v[188:191], v[36:39], v[108:111], v[188:191]
    s_waitcnt lgkmcnt(6)
    v_mfma_f32_16x16x32_bf16 v[144:147], v[40:43], v[112:115], v[144:147]
    v_mfma_f32_16x16x32_bf16 v[160:163], v[44:47], v[112:115], v[160:163]
    v_mfma_f32_16x16x32_bf16 v[176:179], v[48:51], v[112:115], v[176:179]
    s_add_u32 m0, s68, 81920
    s_add_u32 s27, s27, 147456
    buffer_load_dwordx4 v206, s[36:39], s27 offen lds
    ds_read_b64_tr_b16 v[128:129], v74 offset:28672
    ds_read_b64_tr_b16 v[130:131], v74 offset:29184
    ds_read_b128 v[52:55], v73 offset:24576
    ds_read_b128 v[56:59], v73 offset:32768
    ds_read_b128 v[60:63], v73 offset:40960
    buffer_load_dwordx4 v207, s[36:39], s27 offen offset:1024 lds
    ds_read_b64_tr_b16 v[132:133], v75 offset:28672
    ds_read_b64_tr_b16 v[134:135], v75 offset:29184
    s_waitcnt lgkmcnt(11)
    v_mfma_f32_16x16x32_bf16 v[148:151], v[40:43], v[116:119], v[148:151]
    v_mfma_f32_16x16x32_bf16 v[164:167], v[44:47], v[116:119], v[164:167]
    v_mfma_f32_16x16x32_bf16 v[180:183], v[48:51], v[116:119], v[180:183]
    s_add_u32 m0, s68, 90112
    s_add_u32 s27, s27, 147456
    buffer_load_dwordx4 v206, s[36:39], s27 offen lds
    ds_read_b64_tr_b16 v[136:137], v76 offset:28672
    ds_read_b64_tr_b16 v[138:139], v76 offset:29184
    s_waitcnt lgkmcnt(11)
    v_mfma_f32_16x16x32_bf16 v[152:155], v[40:43], v[120:123], v[152:155]
    v_mfma_f32_16x16x32_bf16 v[168:171], v[44:47], v[120:123], v[168:171]
    v_mfma_f32_16x16x32_bf16 v[184:187], v[48:51], v[120:123], v[184:187]
    buffer_load_dwordx4 v207, s[36:39], s27 offen offset:1024 lds
    ds_read_b64_tr_b16 v[140:141], v77 offset:28672
    ds_read_b64_tr_b16 v[142:143], v77 offset:29184
    s_waitcnt lgkmcnt(11)
    v_mfma_f32_16x16x32_bf16 v[156:159], v[40:43], v[124:127], v[156:159]
    v_mfma_f32_16x16x32_bf16 v[172:175], v[44:47], v[124:127], v[172:175]
    v_mfma_f32_16x16x32_bf16 v[188:191], v[48:51], v[124:127], v[188:191]
    s_waitcnt lgkmcnt(6)
    v_mfma_f32_16x16x32_bf16 v[144:147], v[52:55], v[128:131], v[144:147]
    v_mfma_f32_16x16x32_bf16 v[160:163], v[56:59], v[128:131], v[160:163]
    v_mfma_f32_16x16x32_bf16 v[176:179], v[60:63], v[128:131], v[176:179]
    s_waitcnt vmcnt(8)
    s_barrier
    ds_read_b64_tr_b16 v[80:81], v74 offset:32768
    ds_read_b64_tr_b16 v[82:83], v74 offset:33280
    ds_read_b128 v[16:19], v70 offset:0
    ds_read_b128 v[20:23], v70 offset:8192
    ds_read_b128 v[24:27], v70 offset:16384
    ds_read_b64_tr_b16 v[84:85], v75 offset:32768
    ds_read_b64_tr_b16 v[86:87], v75 offset:33280
    s_waitcnt lgkmcnt(11)
    v_mfma_f32_16x16x32_bf16 v[148:151], v[52:55], v[132:135], v[148:151]
    v_mfma_f32_16x16x32_bf16 v[164:167], v[56:59], v[132:135], v[164:167]
    v_mfma_f32_16x16x32_bf16 v[180:183], v[60:63], v[132:135], v[180:183]
    ds_read_b64_tr_b16 v[88:89], v76 offset:32768
    ds_read_b64_tr_b16 v[90:91], v76 offset:33280
    s_waitcnt lgkmcnt(11)
    v_mfma_f32_16x16x32_bf16 v[152:155], v[52:55], v[136:139], v[152:155]
    v_mfma_f32_16x16x32_bf16 v[168:171], v[56:59], v[136:139], v[168:171]
    v_mfma_f32_16x16x32_bf16 v[184:187], v[60:63], v[136:139], v[184:187]
    ds_read_b64_tr_b16 v[92:93], v77 offset:32768
    ds_read_b64_tr_b16 v[94:95], v77 offset:33280
    s_waitcnt lgkmcnt(11)
    v_mfma_f32_16x16x32_bf16 v[156:159], v[52:55], v[140:143], v[156:159]
    v_mfma_f32_16x16x32_bf16 v[172:175], v[56:59], v[140:143], v[172:175]
    v_mfma_f32_16x16x32_bf16 v[188:191], v[60:63], v[140:143], v[188:191]
    s_waitcnt lgkmcnt(6)
    v_mfma_f32_16x16x32_bf16 v[144:147], v[16:19], v[80:83], v[144:147]
    v_mfma_f32_16x16x32_bf16 v[160:163], v[20:23], v[80:83], v[160:163]
    v_mfma_f32_16x16x32_bf16 v[176:179], v[24:27], v[80:83], v[176:179]
    ds_read_b64_tr_b16 v[96:97], v74 offset:36864
    ds_read_b64_tr_b16 v[98:99], v74 offset:37376
    ds_read_b128 v[28:31], v71 offset:0
    ds_read_b128 v[32:35], v71 offset:8192
    ds_read_b128 v[36:39], v71 offset:16384
    ds_read_b64_tr_b16 v[100:101], v75 offset:36864
    ds_read_b64_tr_b16 v[102:103], v75 offset:37376
    s_waitcnt lgkmcnt(11)
    v_mfma_f32_16x16x32_bf16 v[148:151], v[16:19], v[84:87], v[148:151]
    v_mfma_f32_16x16x32_bf16 v[164:167], v[20:23], v[84:87], v[164:167]
    v_mfma_f32_16x16x32_bf16 v[180:183], v[24:27], v[84:87], v[180:183]
    ds_read_b64_tr_b16 v[104:105], v76 offset:36864
    ds_read_b64_tr_b16 v[106:107], v76 offset:37376
    s_waitcnt lgkmcnt(11)
    v_mfma_f32_16x16x32_bf16 v[152:155], v[16:19], v[88:91], v[152:155]
    v_mfma_f32_16x16x32_bf16 v[168:171], v[20:23], v[88:91], v[168:171]
    v_mfma_f32_16x16x32_bf16 v[184:187], v[24:27], v[88:91], v[184:187]
    ds_read_b64_tr_b16 v[108:109], v77 offset:36864
    ds_read_b64_tr_b16 v[110:111], v77 offset:37376
    s_waitcnt lgkmcnt(11)
    v_mfma_f32_16x16x32_bf16 v[156:159], v[16:19], v[92:95], v[156:159]
    v_mfma_f32_16x16x32_bf16 v[172:175], v[20:23], v[92:95], v[172:175]
    v_mfma_f32_16x16x32_bf16 v[188:191], v[24:27], v[92:95], v[188:191]
    s_waitcnt lgkmcnt(6)
    v_mfma_f32_16x16x32_bf16 v[144:147], v[28:31], v[96:99], v[144:147]
    v_mfma_f32_16x16x32_bf16 v[160:163], v[32:35], v[96:99], v[160:163]
    v_mfma_f32_16x16x32_bf16 v[176:179], v[36:39], v[96:99], v[176:179]
    s_waitcnt vmcnt(0)
    s_barrier
    ds_read_b64_tr_b16 v[112:113], v74 offset:40960
    ds_read_b64_tr_b16 v[114:115], v74 offset:41472
    ds_read_b128 v[40:43], v70 offset:24576
    ds_read_b128 v[44:47], v70 offset:32768
    ds_read_b128 v[48:51], v70 offset:40960
    ds_read_b64_tr_b16 v[116:117], v75 offset:40960
    ds_read_b64_tr_b16 v[118:119], v75 offset:41472
    s_waitcnt lgkmcnt(11)
    v_mfma_f32_16x16x32_bf16 v[148:151], v[28:31], v[100:103], v[148:151]
    v_mfma_f32_16x16x32_bf16 v[164:167], v[32:35], v[100:103], v[164:167]
    v_mfma_f32_16x16x32_bf16 v[180:183], v[36:39], v[100:103], v[180:183]
    ds_read_b64_tr_b16 v[120:121], v76 offset:40960
    ds_read_b64_tr_b16 v[122:123], v76 offset:41472
    s_waitcnt lgkmcnt(11)
    v_mfma_f32_16x16x32_bf16 v[152:155], v[28:31], v[104:107], v[152:155]
    v_mfma_f32_16x16x32_bf16 v[168:171], v[32:35], v[104:107], v[168:171]
    v_mfma_f32_16x16x32_bf16 v[184:187], v[36:39], v[104:107], v[184:187]
    ds_read_b64_tr_b16 v[124:125], v77 offset:40960
    ds_read_b64_tr_b16 v[126:127], v77 offset:41472
    s_waitcnt lgkmcnt(11)
    v_mfma_f32_16x16x32_bf16 v[156:159], v[28:31], v[108:111], v[156:159]
    v_mfma_f32_16x16x32_bf16 v[172:175], v[32:35], v[108:111], v[172:175]
    v_mfma_f32_16x16x32_bf16 v[188:191], v[36:39], v[108:111], v[188:191]
    s_waitcnt lgkmcnt(6)
    v_mfma_f32_16x16x32_bf16 v[144:147], v[40:43], v[112:115], v[144:147]
    v_mfma_f32_16x16x32_bf16 v[160:163], v[44:47], v[112:115], v[160:163]
    v_mfma_f32_16x16x32_bf16 v[176:179], v[48:51], v[112:115], v[176:179]
    ds_read_b64_tr_b16 v[128:129], v74 offset:45056
    ds_read_b64_tr_b16 v[130:131], v74 offset:45568
    ds_read_b128 v[52:55], v71 offset:24576
    ds_read_b128 v[56:59], v71 offset:32768
    ds_read_b128 v[60:63], v71 offset:40960
    ds_read_b64_tr_b16 v[132:133], v75 offset:45056
    ds_read_b64_tr_b16 v[134:135], v75 offset:45568
    s_waitcnt lgkmcnt(11)
    v_mfma_f32_16x16x32_bf16 v[148:151], v[40:43], v[116:119], v[148:151]
    v_mfma_f32_16x16x32_bf16 v[164:167], v[44:47], v[116:119], v[164:167]
    v_mfma_f32_16x16x32_bf16 v[180:183], v[48:51], v[116:119], v[180:183]
    ds_read_b64_tr_b16 v[136:137], v76 offset:45056
    ds_read_b64_tr_b16 v[138:139], v76 offset:45568
    s_waitcnt lgkmcnt(11)
    v_mfma_f32_16x16x32_bf16 v[152:155], v[40:43], v[120:123], v[152:155]
    v_mfma_f32_16x16x32_bf16 v[168:171], v[44:47], v[120:123], v[168:171]
    v_mfma_f32_16x16x32_bf16 v[184:187], v[48:51], v[120:123], v[184:187]
    ds_read_b64_tr_b16 v[140:141], v77 offset:45056
    ds_read_b64_tr_b16 v[142:143], v77 offset:45568
    s_waitcnt lgkmcnt(11)
    v_mfma_f32_16x16x32_bf16 v[156:159], v[40:43], v[124:127], v[156:159]
    v_mfma_f32_16x16x32_bf16 v[172:175], v[44:47], v[124:127], v[172:175]
    v_mfma_f32_16x16x32_bf16 v[188:191], v[48:51], v[124:127], v[188:191]
    s_waitcnt lgkmcnt(6)
    v_mfma_f32_16x16x32_bf16 v[144:147], v[52:55], v[128:131], v[144:147]
    v_mfma_f32_16x16x32_bf16 v[160:163], v[56:59], v[128:131], v[160:163]
    v_mfma_f32_16x16x32_bf16 v[176:179], v[60:63], v[128:131], v[176:179]
    s_waitcnt lgkmcnt(4)
    v_mfma_f32_16x16x32_bf16 v[148:151], v[52:55], v[132:135], v[148:151]
    v_mfma_f32_16x16x32_bf16 v[164:167], v[56:59], v[132:135], v[164:167]
    v_mfma_f32_16x16x32_bf16 v[180:183], v[60:63], v[132:135], v[180:183]
    s_waitcnt lgkmcnt(2)
    v_mfma_f32_16x16x32_bf16 v[152:155], v[52:55], v[136:139], v[152:155]
    v_mfma_f32_16x16x32_bf16 v[168:171], v[56:59], v[136:139], v[168:171]
    v_mfma_f32_16x16x32_bf16 v[184:187], v[60:63], v[136:139], v[184:187]
    s_waitcnt lgkmcnt(0)
    v_mfma_f32_16x16x32_bf16 v[156:159], v[52:55], v[140:143], v[156:159]
    v_mfma_f32_16x16x32_bf16 v[172:175], v[56:59], v[140:143], v[172:175]
    v_mfma_f32_16x16x32_bf16 v[188:191], v[60:63], v[140:143], v[188:191]
L_prod_epi3:
    s_nop 0
    v_cvt_pk_bf16_f32 v80, v144, v145
    v_cvt_pk_bf16_f32 v81, v146, v147
    v_cvt_pk_bf16_f32 v82, v148, v149
    v_cvt_pk_bf16_f32 v83, v150, v151
    v_cvt_pk_bf16_f32 v84, v152, v153
    v_cvt_pk_bf16_f32 v85, v154, v155
    v_cvt_pk_bf16_f32 v86, v156, v157
    v_cvt_pk_bf16_f32 v87, v158, v159
    v_permlane16_swap_b32 v80, v82
    v_permlane16_swap_b32 v81, v83
    v_permlane16_swap_b32 v84, v86
    v_permlane16_swap_b32 v85, v87
    buffer_store_dwordx4 v[80:83], v9, s[32:35], s16 offen sc1
    buffer_store_dwordx4 v[84:87], v9, s[32:35], s17 offen sc1
    v_mfma_f32_16x16x32_bf16 v[192:195], v[208:211], v[80:83], 0
    v_mfma_f32_16x16x32_bf16 v[196:199], v[208:211], v[84:87], 0
    v_add_u32 v9, 12288, v9
    v_cvt_pk_bf16_f32 v88, v160, v161
    v_cvt_pk_bf16_f32 v89, v162, v163
    v_cvt_pk_bf16_f32 v90, v164, v165
    v_cvt_pk_bf16_f32 v91, v166, v167
    v_cvt_pk_bf16_f32 v92, v168, v169
    v_cvt_pk_bf16_f32 v93, v170, v171
    v_cvt_pk_bf16_f32 v94, v172, v173
    v_cvt_pk_bf16_f32 v95, v174, v175
    v_permlane16_swap_b32 v88, v90
    v_permlane16_swap_b32 v89, v91
    v_permlane16_swap_b32 v92, v94
    v_permlane16_swap_b32 v93, v95
    buffer_store_dwordx4 v[88:91], v9, s[32:35], s16 offen sc1
    buffer_store_dwordx4 v[92:95], v9, s[32:35], s17 offen sc1
    v_mfma_f32_16x16x32_bf16 v[192:195], v[208:211], v[88:91], v[192:195]
    v_mfma_f32_16x16x32_bf16 v[196:199], v[208:211], v[92:95], v[196:199]
    v_add_u32 v9, 12288, v9
    v_cvt_pk_bf16_f32 v96, v176, v177
    v_cvt_pk_bf16_f32 v97, v178, v179
    v_cvt_pk_bf16_f32 v98, v180, v181
    v_cvt_pk_bf16_f32 v99, v182, v183
    v_cvt_pk_bf16_f32 v100, v184, v185
    v_cvt_pk_bf16_f32 v101, v186, v187
    v_cvt_pk_bf16_f32 v102, v188, v189
    v_cvt_pk_bf16_f32 v103, v190, v191
    v_permlane16_swap_b32 v96, v98
    v_permlane16_swap_b32 v97, v99
    v_permlane16_swap_b32 v100, v102
    v_permlane16_swap_b32 v101, v103
    buffer_store_dwordx4 v[96:99], v9, s[32:35], s16 offen sc1
    buffer_store_dwordx4 v[100:103], v9, s[32:35], s17 offen sc1
    v_mfma_f32_16x16x32_bf16 v[192:195], v[208:211], v[96:99], v[192:195]
    v_mfma_f32_16x16x32_bf16 v[196:199], v[208:211], v[100:103], v[196:199]
    s_nop 6
    s_mov_b32 exec_lo, 0xffff
    s_mov_b32 exec_hi, 0xffff
    buffer_store_dword v192, v212, s[32:35], s71 offen sc1
    buffer_store_dword v196, v212, s[32:35], s72 offen sc1
    s_mov_b64 exec, -1
    s_branch L_prod_fin
L_prod_rows:
    v_mov_b32 v74, v7
    v_xor_b32 v75, 64, v7
    s_waitcnt vmcnt(12)
    s_barrier
    s_add_u32 m0, s68, 16384
    s_add_u32 s27, s63, 256
    buffer_load_dwordx4 v200, s[40:43], s61 offen lds
    ds_read_b128 v[80:83], v74 offset:0
    ds_read_b128 v[16:19], v70 offset:0
    ds_read_b128 v[20:23], v70 offset:8192
    ds_read_b128 v[24:27], v70 offset:16384
    buffer_load_dwordx4 v201, s[40:43], s61 offen offset:1024 lds
    ds_read_b128 v[84:87], v74 offset:2048
    s_add_u32 m0, s68, 98304
    s_add_u32 s61, s61, s26
    buffer_load_dwordx4 v206, s[36:39], s27 offen lds
    ds_read_b128 v[88:91], v74 offset:4096
    buffer_load_dwordx4 v207, s[36:39], s27 offen offset:1024 lds
    ds_read_b128 v[92:95], v74 offset:6144
    s_waitcnt lgkmcnt(3)
    v_mfma_f32_16x16x32_bf16 v[144:147], v[16:19], v[80:83], 0
    v_mfma_f32_16x16x32_bf16 v[160:163], v[20:23], v[80:83], 0
    v_mfma_f32_16x16x32_bf16 v[176:179], v[24:27], v[80:83], 0
    s_add_u32 m0, s68, 106496
    s_add_u32 s27, s27, 147456
    buffer_load_dwordx4 v206, s[36:39], s27 offen lds
    ds_read_b128 v[96:99], v75 offset:0
    ds_read_b128 v[28:31], v71 offset:0
    ds_read_b128 v[32:35], v71 offset:8192
    ds_read_b128 v[36:39], v71 offset:16384
    buffer_load_dwordx4 v207, s[36:39], s27 offen offset:1024 lds
    ds_read_b128 v[100:103], v75 offset:2048
    s_add_u32 m0, s68, 114688
    s_add_u32 s27, s27, 147456
    buffer_load_dwordx4 v206, s[36:39], s27 offen lds
    ds_read_b128 v[104:107], v75 offset:4096
    buffer_load_dwordx4 v207, s[36:39], s27 offen offset:1024 lds
    ds_read_b128 v[108:111], v75 offset:6144
    s_waitcnt lgkmcnt(9)
    v_mfma_f32_16x16x32_bf16 v[148:151], v[16:19], v[84:87], 0
    v_mfma_f32_16x16x32_bf16 v[164:167], v[20:23], v[84:87], 0
    v_mfma_f32_16x16x32_bf16 v[180:183], v[24:27], v[84:87], 0
    s_waitcnt lgkmcnt(8)
    v_mfma_f32_16x16x32_bf16 v[152:155], v[16:19], v[88:91], 0
    v_mfma_f32_16x16x32_bf16 v[168:171], v[20:23], v[88:91], 0
    v_mfma_f32_16x16x32_bf16 v[184:187], v[24:27], v[88:91], 0
    s_waitcnt lgkmcnt(7)
    v_mfma_f32_16x16x32_bf16 v[156:159], v[16:19], v[92:95], 0
    v_mfma_f32_16x16x32_bf16 v[172:175], v[20:23], v[92:95], 0
    v_mfma_f32_16x16x32_bf16 v[188:191], v[24:27], v[92:95], 0
    s_waitcnt lgkmcnt(3)
    v_mfma_f32_16x16x32_bf16 v[144:147], v[28:31], v[96:99], v[144:147]
    v_mfma_f32_16x16x32_bf16 v[160:163], v[32:35], v[96:99], v[160:163]
    v_mfma_f32_16x16x32_bf16 v[176:179], v[36:39], v[96:99], v[176:179]
    s_waitcnt vmcnt(8)
    s_barrier
    s_add_u32 m0, s68, 24576
    s_add_u32 s27, s63, 384
    buffer_load_dwordx4 v200, s[40:43], s61 offen lds
    ds_read_b128 v[112:115], v74 offset:8192
    ds_read_b128 v[40:43], v70 offset:24576
    ds_read_b128 v[44:47], v70 offset:32768
    ds_read_b128 v[48:51], v70 offset:40960
    buffer_load_dwordx4 v201, s[40:43], s61 offen offset:1024 lds
    ds_read_b128 v[116:119], v74 offset:10240
    s_add_u32 m0, s68, 122880
    s_add_u32 s61, s61, s26
    buffer_load_dwordx4 v206, s[36:39], s27 offen lds
    ds_read_b128 v[120:123], v74 offset:12288
    buffer_load_dwordx4 v207, s[36:39], s27 offen offset:1024 lds
    ds_read_b128 v[124:127], v74 offset:14336
    s_waitcnt lgkmcnt(9)
    v_mfma_f32_16x16x32_bf16 v[148:151], v[28:31], v[100:103], v[148:151]
    v_mfma_f32_16x16x32_bf16 v[164:167], v[32:35], v[100:103], v[164:167]
    v_mfma_f32_16x16x32_bf16 v[180:183], v[36:39], v[100:103], v[180:183]
    s_waitcnt lgkmcnt(8)
    v_mfma_f32_16x16x32_bf16 v[152:155], v[28:31], v[104:107], v[152:155]
    v_mfma_f32_16x16x32_bf16 v[168:171], v[32:35], v[104:107], v[168:171]
    v_mfma_f32_16x16x32_bf16 v[184:187], v[36:39], v[104:107], v[184:187]
    s_waitcnt lgkmcnt(7)
    v_mfma_f32_16x16x32_bf16 v[156:159], v[28:31], v[108:111], v[156:159]
    v_mfma_f32_16x16x32_bf16 v[172:175], v[32:35], v[108:111], v[172:175]
    v_mfma_f32_16x16x32_bf16 v[188:191], v[36:39], v[108:111], v[188:191]
    s_waitcnt lgkmcnt(3)
    v_mfma_f32_16x16x32_bf16 v[144:147], v[40:43], v[112:115], v[144:147]
    v_mfma_f32_16x16x32_bf16 v[160:163], v[44:47], v[112:115], v[160:163]
    v_mfma_f32_16x16x32_bf16 v[176:179], v[48:51], v[112:115], v[176:179]
    s_add_u32 m0, s68, 131072
    s_add_u32 s27, s27, 147456
    buffer_load_dwordx4 v206, s[36:39], s27 offen lds
    ds_read_b128 v[128:131], v75 offset:8192
    ds_read_b128 v[52:55], v71 offset:24576
    ds_read_b128 v[56:59], v71 offset:32768
    ds_read_b128 v[60:63], v71 offset:40960
    buffer_load_dwordx4 v207, s[36:39], s27 offen offset:1024 lds
    ds_read_b128 v[132:135], v75 offset:10240
    s_add_u32 m0, s68, 139264
    s_add_u32 s27, s27, 147456
    buffer_load_dwordx4 v206, s[36:39], s27 offen lds
    ds_read_b128 v[136:139], v75 offset:12288
    buffer_load_dwordx4 v207, s[36:39], s27 offen offset:1024 lds
    ds_read_b128 v[140:143], v75 offset:14336
    s_waitcnt lgkmcnt(9)
    v_mfma_f32_16x16x32_bf16 v[148:151], v[40:43], v[116:119], v[148:151]
    v_mfma_f32_16x16x32_bf16 v[164:167], v[44:47], v[116:119], v[164:167]
    v_mfma_f32_16x16x32_bf16 v[180:183], v[48:51], v[116:119], v[180:183]
    s_waitcnt lgkmcnt(8)
    v_mfma_f32_16x16x32_bf16 v[152:155], v[40:43], v[120:123], v[152:155]
    v_mfma_f32_16x16x32_bf16 v[168:171], v[44:47], v[120:123], v[168:171]
    v_mfma_f32_16x16x32_bf16 v[184:187], v[48:51], v[120:123], v[184:187]
    s_waitcnt lgkmcnt(7)
    v_mfma_f32_16x16x32_bf16 v[156:159], v[40:43], v[124:127], v[156:159]
    v_mfma_f32_16x16x32_bf16 v[172:175], v[44:47], v[124:127], v[172:175]
    v_mfma_f32_16x16x32_bf16 v[188:191], v[48:51], v[124:127], v[188:191]
    s_waitcnt lgkmcnt(3)
    v_mfma_f32_16x16x32_bf16 v[144:147], v[52:55], v[128:131], v[144:147]
    v_mfma_f32_16x16x32_bf16 v[160:163], v[56:59], v[128:131], v[160:163]
    v_mfma_f32_16x16x32_bf16 v[176:179], v[60:63], v[128:131], v[176:179]
    s_waitcnt vmcnt(8)
    s_barrier
    s_add_u32 m0, s68, 32768
    s_add_u32 s27, s63, 512
    buffer_load_dwordx4 v200, s[40:43], s61 offen lds
    ds_read_b128 v[80:83], v74 offset:16384
    ds_read_b128 v[16:19], v72 offset:0
    ds_read_b128 v[20:23], v72 offset:8192
    ds_read_b128 v[24:27], v72 offset:16384
    buffer_load_dwordx4 v201, s[40:43], s61 offen offset:1024 lds
    ds_read_b128 v[84:87], v74 offset:18432
    s_add_u32 m0, s68, 49152
    s_add_u32 s61, s61, s26
    buffer_load_dwordx4 v206, s[36:39], s27 offen lds
    ds_read_b128 v[88:91], v74 offset:20480
    buffer_load_dwordx4 v207, s[36:39], s27 offen offset:1024 lds
    ds_read_b128 v[92:95], v74 offset:22528
    s_waitcnt lgkmcnt(9)
    v_mfma_f32_16x16x32_bf16 v[148:151], v[52:55], v[132:135], v[148:151]
    v_mfma_f32_16x16x32_bf16 v[164:167], v[56:59], v[132:135], v[164:167]
    v_mfma_f32_16x16x32_bf16 v[180:183], v[60:63], v[132:135], v[180:183]
    s_waitcnt lgkmcnt(8)
    v_mfma_f32_16x16x32_bf16 v[152:155], v[52:55], v[136:139], v[152:155]
    v_mfma_f32_16x16x32_bf16 v[168:171], v[56:59], v[136:139], v[168:171]
    v_mfma_f32_16x16x32_bf16 v[184:187], v[60:63], v[136:139], v[184:187]
    s_waitcnt lgkmcnt(7)
    v_mfma_f32_16x16x32_bf16 v[156:159], v[52:55], v[140:143], v[156:159]
    v_mfma_f32_16x16x32_bf16 v[172:175], v[56:59], v[140:143], v[172:175]
    v_mfma_f32_16x16x32_bf16 v[188:191], v[60:63], v[140:143], v[188:191]
    s_waitcnt lgkmcnt(3)
    v_mfma_f32_16x16x32_bf16 v[144:147], v[16:19], v[80:83], v[144:147]
    v_mfma_f32_16x16x32_bf16 v[160:163], v[20:23], v[80:83], v[160:163]
    v_mfma_f32_16x16x32_bf16 v[176:179], v[24:27], v[80:83], v[176:179]
    s_add_u32 m0, s68, 57344
    s_add_u32 s27, s27, 147456
    buffer_load_dwordx4 v206, s[36:39], s27 offen lds
    ds_read_b128 v[96:99], v75 offset:16384
    ds_read_b128 v[28:31], v73 offset:0
    ds_read_b128 v[32:35], v73 offset:8192
    ds_read_b128 v[36:39], v73 offset:16384
    buffer_load_dwordx4 v207, s[36:39], s27 offen offset:1024 lds
    ds_read_b128 v[100:103], v75 offset:18432
    s_add_u32 m0, s68, 65536
    s_add_u32 s27, s27, 147456
    buffer_load_dwordx4 v206, s[36:39], s27 offen lds
    ds_read_b128 v[104:107], v75 offset:20480
    buffer_load_dwordx4 v207, s[36:39], s27 offen offset:1024 lds
    ds_read_b128 v[108:111], v75 offset:22528
    s_waitcnt lgkmcnt(9)
    v_mfma_f32_16x16x32_bf16 v[148:151], v[16:19], v[84:87], v[148:151]
    v_mfma_f32_16x16x32_bf16 v[164:167], v[20:23], v[84:87], v[164:167]
    v_mfma_f32_16x16x32_bf16 v[180:183], v[24:27], v[84:87], v[180:183]
    s_waitcnt lgkmcnt(8)
    v_mfma_f32_16x16x32_bf16 v[152:155], v[16:19], v[88:91], v[152:155]
    v_mfma_f32_16x16x32_bf16 v[168:171], v[20:23], v[88:91], v[168:171]
    v_mfma_f32_16x16x32_bf16 v[184:187], v[24:27], v[88:91], v[184:187]
    s_waitcnt lgkmcnt(7)
    v_mfma_f32_16x16x32_bf16 v[156:159], v[16:19], v[92:95], v[156:159]
    v_mfma_f32_16x16x32_bf16 v[172:175], v[20:23], v[92:95], v[172:175]
    v_mfma_f32_16x16x32_bf16 v[188:191], v[24:27], v[92:95], v[188:191]
    s_waitcnt lgkmcnt(3)
    v_mfma_f32_16x16x32_bf16 v[144:147], v[28:31], v[96:99], v[144:147]
    v_mfma_f32_16x16x32_bf16 v[160:163], v[32:35], v[96:99], v[160:163]
    v_mfma_f32_16x16x32_bf16 v[176:179], v[36:39], v[96:99], v[176:179]
    s_waitcnt vmcnt(8)
    s_barrier
    s_add_u32 m0, s68, 40960
    s_add_u32 s27, s63, 640
    buffer_load_dwordx4 v200, s[40:43], s61 offen lds
    ds_read_b128 v[112:115], v74 offset:24576
    ds_read_b128 v[40:43], v72 offset:24576
    ds_read_b128 v[44:47], v72 offset:32768
    ds_read_b128 v[48:51], v72 offset:40960
    buffer_load_dwordx4 v201, s[40:43], s61 offen offset:1024 lds
    ds_read_b128 v[116:119], v74 offset:26624
    s_add_u32 m0, s68, 73728
    s_add_u32 s61, s61, s26
    buffer_load_dwordx4 v206, s[36:39], s27 offen lds
    ds_read_b128 v[120:123], v74 offset:28672
    buffer_load_dwordx4 v207, s[36:39], s27 offen offset:1024 lds
    ds_read_b128 v[124:127], v74 offset:30720
    s_waitcnt lgkmcnt(9)
    v_mfma_f32_16x16x32_bf16 v[148:151], v[28:31], v[100:103], v[148:151]
    v_mfma_f32_16x16x32_bf16 v[164:167], v[32:35], v[100:103], v[164:167]
    v_mfma_f32_16x16x32_bf16 v[180:183], v[36:39], v[100:103], v[180:183]
    s_waitcnt lgkmcnt(8)
    v_mfma_f32_16x16x32_bf16 v[152:155], v[28:31], v[104:107], v[152:155]
    v_mfma_f32_16x16x32_bf16 v[168:171], v[32:35], v[104:107], v[168:171]
    v_mfma_f32_16x16x32_bf16 v[184:187], v[36:39], v[104:107], v[184:187]
    s_waitcnt lgkmcnt(7)
    v_mfma_f32_16x16x32_bf16 v[156:159], v[28:31], v[108:111], v[156:159]
    v_mfma_f32_16x16x32_bf16 v[172:175], v[32:35], v[108:111], v[172:175]
    v_mfma_f32_16x16x32_bf16 v[188:191], v[36:39], v[108:111], v[188:191]
    s_waitcnt lgkmcnt(3)
    v_mfma_f32_16x16x32_bf16 v[144:147], v[40:43], v[112:115], v[144:147]
    v_mfma_f32_16x16x32_bf16 v[160:163], v[44:47], v[112:115], v[160:163]
    v_mfma_f32_16x16x32_bf16 v[176:179], v[48:51], v[112:115], v[176:179]
    s_add_u32 m0, s68, 81920
    s_add_u32 s27, s27, 147456
    buffer_load_dwordx4 v206, s[36:39], s27 offen lds
    ds_read_b128 v[128:131], v75 offset:24576
    ds_read_b128 v[52:55], v73 offset:24576
    ds_read_b128 v[56:59], v73 offset:32768
    ds_read_b128 v[60:63], v73 offset:40960
    buffer_load_dwordx4 v207, s[36:39], s27 offen offset:1024 lds
    ds_read_b128 v[132:135], v75 offset:26624
    s_add_u32 m0, s68, 90112
    s_add_u32 s27, s27, 147456
    buffer_load_dwordx4 v206, s[36:39], s27 offen lds
    ds_read_b128 v[136:139], v75 offset:28672
    buffer_load_dwordx4 v207, s[36:39], s27 offen offset:1024 lds
    ds_read_b128 v[140:143], v75 offset:30720
    s_waitcnt lgkmcnt(9)
    v_mfma_f32_16x16x32_bf16 v[148:151], v[40:43], v[116:119], v[148:151]
    v_mfma_f32_16x16x32_bf16 v[164:167], v[44:47], v[116:119], v[164:167]
    v_mfma_f32_16x16x32_bf16 v[180:183], v[48:51], v[116:119], v[180:183]
    s_waitcnt lgkmcnt(8)
    v_mfma_f32_16x16x32_bf16 v[152:155], v[40:43], v[120:123], v[152:155]
    v_mfma_f32_16x16x32_bf16 v[168:171], v[44:47], v[120:123], v[168:171]
    v_mfma_f32_16x16x32_bf16 v[184:187], v[48:51], v[120:123], v[184:187]
    s_waitcnt lgkmcnt(7)
    v_mfma_f32_16x16x32_bf16 v[156:159], v[40:43], v[124:127], v[156:159]
    v_mfma_f32_16x16x32_bf16 v[172:175], v[44:47], v[124:127], v[172:175]
    v_mfma_f32_16x16x32_bf16 v[188:191], v[48:51], v[124:127], v[188:191]
    s_waitcnt lgkmcnt(3)
    v_mfma_f32_16x16x32_bf16 v[144:147], v[52:55], v[128:131], v[144:147]
    v_mfma_f32_16x16x32_bf16 v[160:163], v[56:59], v[128:131], v[160:163]
    v_mfma_f32_16x16x32_bf16 v[176:179], v[60:63], v[128:131], v[176:179]
    s_waitcnt vmcnt(8)
    s_barrier
    ds_read_b128 v[80:83], v74 offset:32768
    ds_read_b128 v[16:19], v70 offset:0
    ds_read_b128 v[20:23], v70 offset:8192
    ds_read_b128 v[24:27], v70 offset:16384
    ds_read_b128 v[84:87], v74 offset:34816
    ds_read_b128 v[88:91], v74 offset:36864
    ds_read_b128 v[92:95], v74 offset:38912
    s_waitcnt lgkmcnt(9)
    v_mfma_f32_16x16x32_bf16 v[148:151], v[52:55], v[132:135], v[148:151]
    v_mfma_f32_16x16x32_bf16 v[164:167], v[56:59], v[132:135], v[164:167]
    v_mfma_f32_16x16x32_bf16 v[180:183], v[60:63], v[132:135], v[180:183]
    s_waitcnt lgkmcnt(8)
    v_mfma_f32_16x16x32_bf16 v[152:155], v[52:55], v[136:139], v[152:155]
    v_mfma_f32_16x16x32_bf16 v[168:171], v[56:59], v[136:139], v[168:171]
    v_mfma_f32_16x16x32_bf16 v[184:187], v[60:63], v[136:139], v[184:187]
    s_waitcnt lgkmcnt(7)
    v_mfma_f32_16x16x32_bf16 v[156:159], v[52:55], v[140:143], v[156:159]
    v_mfma_f32_16x16x32_bf16 v[172:175], v[56:59], v[140:143], v[172:175]
    v_mfma_f32_16x16x32_bf16 v[188:191], v[60:63], v[140:143], v[188:191]
    s_waitcnt lgkmcnt(3)
    v_mfma_f32_16x16x32_bf16 v[144:147], v[16:19], v[80:83], v[144:147]
    v_mfma_f32_16x16x32_bf16 v[160:163], v[20:23], v[80:83], v[160:163]
    v_mfma_f32_16x16x32_bf16 v[176:179], v[24:27], v[80:83], v[176:179]
    ds_read_b128 v[96:99], v75 offset:32768
    ds_read_b128 v[28:31], v71 offset:0
    ds_read_b128 v[32:35], v71 offset:8192
    ds_read_b128 v[36:39], v71 offset:16384
    ds_read_b128 v[100:103], v75 offset:34816
    ds_read_b128 v[104:107], v75 offset:36864
    ds_read_b128 v[108:111], v75 offset:38912
    s_waitcnt lgkmcnt(9)
    v_mfma_f32_16x16x32_bf16 v[148:151], v[16:19], v[84:87], v[148:151]
    v_mfma_f32_16x16x32_bf16 v[164:167], v[20:23], v[84:87], v[164:167]
    v_mfma_f32_16x16x32_bf16 v[180:183], v[24:27], v[84:87], v[180:183]
    s_waitcnt lgkmcnt(8)
    v_mfma_f32_16x16x32_bf16 v[152:155], v[16:19], v[88:91], v[152:155]
    v_mfma_f32_16x16x32_bf16 v[168:171], v[20:23], v[88:91], v[168:171]
    v_mfma_f32_16x16x32_bf16 v[184:187], v[24:27], v[88:91], v[184:187]
    s_waitcnt lgkmcnt(7)
    v_mfma_f32_16x16x32_bf16 v[156:159], v[16:19], v[92:95], v[156:159]
    v_mfma_f32_16x16x32_bf16 v[172:175], v[20:23], v[92:95], v[172:175]
    v_mfma_f32_16x16x32_bf16 v[188:191], v[24:27], v[92:95], v[188:191]
    s_waitcnt lgkmcnt(3)
    v_mfma_f32_16x16x32_bf16 v[144:147], v[28:31], v[96:99], v[144:147]
    v_mfma_f32_16x16x32_bf16 v[160:163], v[32:35], v[96:99], v[160:163]
    v_mfma_f32_16x16x32_bf16 v[176:179], v[36:39], v[96:99], v[176:179]
    s_waitcnt vmcnt(0)
    s_barrier
    ds_read_b128 v[112:115], v74 offset:40960
    ds_read_b128 v[40:43], v70 offset:24576
    ds_read_b128 v[44:47], v70 offset:32768
    ds_read_b128 v[48:51], v70 offset:40960
    ds_read_b128 v[116:119], v74 offset:43008
    ds_read_b128 v[120:123], v74 offset:45056
    ds_read_b128 v[124:127], v74 offset:47104
    s_waitcnt lgkmcnt(9)
    v_mfma_f32_16x16x32_bf16 v[148:151], v[28:31], v[100:103], v[148:151]
    v_mfma_f32_16x16x32_bf16 v[164:167], v[32:35], v[100:103], v[164:167]
    v_mfma_f32_16x16x32_bf16 v[180:183], v[36:39], v[100:103], v[180:183]
    s_waitcnt lgkmcnt(8)
    v_mfma_f32_16x16x32_bf16 v[152:155], v[28:31], v[104:107], v[152:155]
    v_mfma_f32_16x16x32_bf16 v[168:171], v[32:35], v[104:107], v[168:171]
    v_mfma_f32_16x16x32_bf16 v[184:187], v[36:39], v[104:107], v[184:187]
    s_waitcnt lgkmcnt(7)
    v_mfma_f32_16x16x32_bf16 v[156:159], v[28:31], v[108:111], v[156:159]
    v_mfma_f32_16x16x32_bf16 v[172:175], v[32:35], v[108:111], v[172:175]
    v_mfma_f32_16x16x32_bf16 v[188:191], v[36:39], v[108:111], v[188:191]
    s_waitcnt lgkmcnt(3)
    v_mfma_f32_16x16x32_bf16 v[144:147], v[40:43], v[112:115], v[144:147]
    v_mfma_f32_16x16x32_bf16 v[160:163], v[44:47], v[112:115], v[160:163]
    v_mfma_f32_16x16x32_bf16 v[176:179], v[48:51], v[112:115], v[176:179]
    ds_read_b128 v[128:131], v75 offset:40960
    ds_read_b128 v[52:55], v71 offset:24576
    ds_read_b128 v[56:59], v71 offset:32768
    ds_read_b128 v[60:63], v71 offset:40960
    ds_read_b128 v[132:135], v75 offset:43008
    ds_read_b128 v[136:139], v75 offset:45056
    ds_read_b128 v[140:143], v75 offset:47104
    s_waitcnt lgkmcnt(9)
    v_mfma_f32_16x16x32_bf16 v[148:151], v[40:43], v[116:119], v[148:151]
    v_mfma_f32_16x16x32_bf16 v[164:167], v[44:47], v[116:119], v[164:167]
    v_mfma_f32_16x16x32_bf16 v[180:183], v[48:51], v[116:119], v[180:183]
    s_waitcnt lgkmcnt(8)
    v_mfma_f32_16x16x32_bf16 v[152:155], v[40:43], v[120:123], v[152:155]
    v_mfma_f32_16x16x32_bf16 v[168:171], v[44:47], v[120:123], v[168:171]
    v_mfma_f32_16x16x32_bf16 v[184:187], v[48:51], v[120:123], v[184:187]
    s_waitcnt lgkmcnt(7)
    v_mfma_f32_16x16x32_bf16 v[156:159], v[40:43], v[124:127], v[156:159]
    v_mfma_f32_16x16x32_bf16 v[172:175], v[44:47], v[124:127], v[172:175]
    v_mfma_f32_16x16x32_bf16 v[188:191], v[48:51], v[124:127], v[188:191]
    s_waitcnt lgkmcnt(3)
    v_mfma_f32_16x16x32_bf16 v[144:147], v[52:55], v[128:131], v[144:147]
    v_mfma_f32_16x16x32_bf16 v[160:163], v[56:59], v[128:131], v[160:163]
    v_mfma_f32_16x16x32_bf16 v[176:179], v[60:63], v[128:131], v[176:179]
    s_waitcnt lgkmcnt(2)
    v_mfma_f32_16x16x32_bf16 v[148:151], v[52:55], v[132:135], v[148:151]
    v_mfma_f32_16x16x32_bf16 v[164:167], v[56:59], v[132:135], v[164:167]
    v_mfma_f32_16x16x32_bf16 v[180:183], v[60:63], v[132:135], v[180:183]
    s_waitcnt lgkmcnt(1)
    v_mfma_f32_16x16x32_bf16 v[152:155], v[52:55], v[136:139], v[152:155]
    v_mfma_f32_16x16x32_bf16 v[168:171], v[56:59], v[136:139], v[168:171]
    v_mfma_f32_16x16x32_bf16 v[184:187], v[60:63], v[136:139], v[184:187]
    s_waitcnt lgkmcnt(0)
    v_mfma_f32_16x16x32_bf16 v[156:159], v[52:55], v[140:143], v[156:159]
    v_mfma_f32_16x16x32_bf16 v[172:175], v[56:59], v[140:143], v[172:175]
    v_mfma_f32_16x16x32_bf16 v[188:191], v[60:63], v[140:143], v[188:191]
    s_branch L_prod_epi3
L_prod_idle:
    s_mov_b32 s32, s18
    s_mov_b32 s33, s19
    s_mov_b32 s44, s14
    s_mov_b32 s45, s15
    s_mov_b32 s46, 1572864
    s_mov_b32 s47, 0x20000
    s_mov_b32 s58, 0x3f803f80
    s_getreg_b32 s24, hwreg(HW_REG_XCC_ID, 0, 3)
    v_mov_b32 v12, s58
    v_mov_b32 v13, s58
    v_mov_b32 v14, s58
    v_mov_b32 v15, s58
    v_mov_b32 v69, 0xffffff00
    v_mov_b32 v228, 0
    v_cmp_eq_u32 s[50:51], 0, v3
    v_lshrrev_b32 v4, 1, v3
    v_lshrrev_b32 v5, 3, v2
    v_cmp_eq_u32 s[48:49], v4, v5
    v_lshrrev_b32 v5, 2, v2
    v_cmp_eq_u32 s[100:101], v3, v5
    s_lshl_b32 s27, s20, 7
    s_add_u32 s27, s27, 4096
    v_and_b32 v5, 31, v1
    v_lshlrev_b32 v5, 10, v5
    v_add_u32 v230, s27, v5
    v_min_u32 v231, 11, v1
    s_mul_i32 s28, s20, 12288
    v_lshlrev_b32 v231, 7, v231
    s_bitcmp0_b32 s21, 3
    s_cselect_b32 s27, 0, 1536
    s_add_u32 s27, s27, 6390272
    s_add_u32 s27, s27, s28
    v_add_u32 v231, s27, v231
    v_min_u32 v4, 5, v1
    v_mul_u32_u24 v4, 768, v4
    s_lshl_b32 s27, s60, 7
    s_add_u32 s27, s27, s28
    s_add_u32 s27, s27, 6385664
    v_add_u32 v246, s27, v4
    s_waitcnt lgkmcnt(0)
    s_and_b32 s27, s23, 0x78787878
    s_add_u32 s27, s27, 0x08080808
    s_and_b32 s28, s23, 0x80808080
    s_xor_b32 s23, s27, s28
    s_or_b32 s24, s24, s23
    s_lshl_b32 s27, s2, 7
    s_add_u32 s27, s27, 4096
    v_mov_b32 v4, s24
    v_mov_b32 v229, s23
    s_mov_b64 exec, 1
    buffer_store_dword v4, v228, s[32:35], s27 offen sc1
    s_mov_b64 exec, -1
    s_and_b32 s52, s23, 0xff
    s_bfe_u32 s53, s23, 0x80008
    s_bfe_u32 s54, s23, 0x80010
    s_lshr_b32 s55, s23, 24
    s_branch L_prod_help
L_code_end:
.section .rodata,"a"
.p2align 6
.amdhsa_kernel standalone__video_timesformer__vision_kernel
  .amdhsa_next_free_vgpr 512
  .amdhsa_next_free_sgpr 102
  .amdhsa_accum_offset 256
  .amdhsa_group_segment_fixed_size 0
  .amdhsa_kernarg_size 64
  .amdhsa_user_sgpr_count 2
  .amdhsa_user_sgpr_kernarg_segment_ptr 1
  .amdhsa_system_sgpr_workgroup_id_x 1
.end_amdhsa_kernel
```
